```python
import torch

def _softmax(x, axis=-1):
    return torch.softmax(x, dim=axis)
def _gelu(x):
    return torch.nn.functional.gelu(x, approximate="tanh")
def _silu(x):
    return torch.nn.functional.silu(x)
def _sigmoid(x):
    return torch.sigmoid(x)
def _layernorm(x, axis=-1, eps=1e-5):
    m = x.mean(dim=axis, keepdim=True)
    v = x.var(dim=axis, keepdim=True, unbiased=False)
    return (x - m) / torch.sqrt(v + eps)
def _scatter_add(tgt, idx, src, axis=0):
    return tgt.clone().index_add_(axis, idx, src)
def _segment_sum(src, seg, n):
    out = torch.zeros((n,) + src.shape[1:], dtype=src.dtype)
    return out.index_add_(0, seg, src)
def _pad(x, pw):
    flat = tuple(v for pair in reversed(pw) for v in pair)
    return torch.nn.functional.pad(x, flat)

kernel_name = 'standalone__deep_cross_xdeepfm__recsys'

def setup_inputs():

    _w = (lambda a: (lambda t: t.to(torch.bfloat16) if t.is_floating_point() else t)(torch.as_tensor(a)))
    B, F, D, L = 1024, 26, 64, 3
    V = min(1000, 100000)
    Din = F * D
    return {
        "idx": _w((lambda lo, hi, *s: torch.randint(lo, hi, s))(0, V, B, F).to(torch.int64)),
        "table": _w((lambda *s: torch.randn(*s, dtype=torch.bfloat16) * 0.8)(V, D)),
        "ws_cin": _w((lambda *s: torch.randn(*s, dtype=torch.bfloat16) * 0.2)(L, F, F, F) * (1.0 / F)),
        "w_cin_out": _w((lambda *s: torch.randn(*s, dtype=torch.bfloat16) * 0.2)(L * F) * ((L * F) ** -0.5)),
        "w_dnn1": _w((lambda *s: torch.randn(*s, dtype=torch.bfloat16) * 0.8)(Din, Din) * (Din ** -0.5)),
        "b_dnn1": _w((lambda *s: torch.randn(*s, dtype=torch.bfloat16) * 6.4)(Din) * 0.1),
        "w_dnn2": _w((lambda *s: torch.randn(*s, dtype=torch.bfloat16) * 0.2)(Din) * (Din ** -0.5)),
        "b_out": _w((lambda *s: torch.randn(*s, dtype=torch.bfloat16) * 0.4)(1)),
    }

def reference(idx, table, ws_cin, w_cin_out, w_dnn1, b_dnn1, w_dnn2, b_out):
    x0 = table[idx]
    B = x0.shape[0]
    L = ws_cin.shape[0]
    xk = x0
    pooled = []
    for l in range(L):
        xk = torch.einsum('bid,bjd,hij->bhd', xk, x0, ws_cin[l])
        pooled.append(xk.sum(axis=-1))
    p_plus = torch.stack(pooled, axis=1).reshape(B, -1)
    logit_cin = p_plus @ w_cin_out
    h = x0.reshape(B, -1)
    h = _gelu(h @ w_dnn1 + b_dnn1)
    logit_dnn = h @ w_dnn2
    return logit_cin + logit_dnn + b_out
```

```asm
; @launch grid=(256,1,1) block=(512,1,1) lds=163840
.amdgcn_target "amdgcn-amd-amdhsa--gfx950"
.text
.globl standalone__deep_cross_xdeepfm__recsys_kernel
.p2align 8
.type standalone__deep_cross_xdeepfm__recsys_kernel,@function
standalone__deep_cross_xdeepfm__recsys_kernel:
    s_load_dwordx16 s[16:31], s[0:1], 0
    s_load_dwordx4 s[32:35], s[0:1], 64
    s_load_dwordx2 s[36:37], s[0:1], 80
    s_cmp_ge_u32 s2, 256
    s_cbranch_scc1 L_end
    v_lshrrev_b32 v1, 6, v0
    v_and_b32 v2, 63, v0
    v_readfirstlane_b32 s3, v1
    s_and_b32 s4, s2, 7
    s_lshr_b32 s5, s2, 3
    s_cmp_ge_u32 s5, 26
    s_cbranch_scc1 L_aux0
    s_mul_i32 s6, s4, 26
    s_add_u32 s6, s6, s5
    s_and_b32 s8, s6, 7
    s_and_b32 s66, s3, 1
    s_lshr_b32 s68, s3, 1
    s_lshl2_add_u32 s70, s8, s68
    s_mul_i32 s70, s70, 3328
    s_lshl_b32 s71, s66, 11
    s_add_u32 s70, s70, s71
    s_lshl_b32 s69, s68, 13
    s_add_u32 s69, s69, s71
    s_add_u32 m0, s69, 132096
    v_lshlrev_b32 v6, 4, v2
    v_lshrrev_b32 v3, 3, v2
    v_lshrrev_b32 v4, 4, v2
    v_and_b32 v10, 7, v2
    s_lshl_b32 s67, s66, 2
    v_xor_b32 v5, v10, v4
    v_xor_b32 v5, s67, v5
    v_lshlrev_b32 v5, 4, v5
    v_lshl_add_u32 v5, v3, 7, v5
    s_lshl1_add_u32 s69, s5, s68
    s_lshl1_add_u32 s14, s69, s66
    s_lshl_b32 s14, s14, 10
    s_sub_u32 s15, 129024, s71
    s_lshr_b32 s71, s71, 1
    s_add_u32 s65, s15, s71
    s_mov_b32 s42, 106496
    s_mov_b32 s43, 0x20000
    s_mov_b32 s46, 128000
    s_mov_b32 s47, 0x20000
    s_mov_b32 s69, 3
    s_waitcnt lgkmcnt(0)
    s_mov_b64 s[40:41], s[16:17]
    s_mov_b64 s[44:45], s[18:19]
    buffer_load_dwordx4 v6, s[40:43], s70 offen lds
    s_cmp_eq_u32 s66, 0
    s_cselect_b64 exec, -1, 0xffff
    buffer_load_dwordx4 v6, s[40:43], s70 offen offset:1024 lds
    s_mov_b64 exec, -1
L_tl1:
    s_mov_b32 m0, s14
    s_add_u32 s14, s14, 8192
    buffer_load_dwordx4 v5, s[44:47], m0 offen lds
    s_cmp_ge_u32 s14, s65
    s_cselect_b32 s71, s15, 0
    s_sub_u32 s14, s14, s71
    s_sub_u32 s69, s69, 1
    s_cbranch_scc0 L_tl1
    s_cmp_ge_u32 s3, 4
    s_cbranch_scc1 L_help_pro
    s_lshr_b32 s7, s6, 3
    s_lshl_b32 s64, s3, 13
    s_add_u32 s64, s64, 128000
    s_lshl_b32 s73, s3, 5
    v_add_u32 v9, s73, v3
    v_mul_u32_u24 v9, 3328, v9
    v_lshlrev_b32 v11, 1, v4
    v_and_b32 v11, 2, v11
    v_xor_b32 v11, v11, v10
    v_lshl_add_u32 v1, v11, 4, v9
    s_lshl_b32 s73, s7, 7
    v_add_u32 v1, s73, v1
    v_xor_b32 v3, 64, v1
    v_add_u32 v3, 25600, v3
    s_mov_b32 s48, s24
    s_mov_b32 s49, s25
    s_mov_b32 s50, 5537792
    s_mov_b32 s51, 0x20000
    s_add_u32 m0, s64, 0
    s_mov_b32 s12, 0
    buffer_load_dwordx4 v1, s[48:51], s12 offen offset:0 lds
    buffer_load_dwordx4 v3, s[48:51], s12 offen offset:1024 lds
    s_add_u32 m0, s64, 2048
    s_mov_b32 s12, 53248
    buffer_load_dwordx4 v1, s[48:51], s12 offen offset:0 lds
    buffer_load_dwordx4 v3, s[48:51], s12 offen offset:1024 lds
    s_branch L_dnn_b
L_help_pro:
    s_sub_u32 s72, s3, 4
    s_lshl2_add_u32 s6, s5, s72
    s_lshl_b32 s72, s4, 7
    s_add_u32 s6, s6, s72
    s_mul_i32 s72, s6, 104
    v_lshlrev_b32 v30, 2, v2
    buffer_load_dword v29, v30, s[40:43], s72 offen
    s_mov_b32 s69, 1
L_tl5:
    s_mov_b32 m0, s14
    s_add_u32 s14, s14, 8192
    buffer_load_dwordx4 v5, s[44:47], m0 offen lds
    s_cmp_ge_u32 s14, s65
    s_cselect_b32 s71, s15, 0
    s_sub_u32 s14, s14, s71
    s_sub_u32 s69, s69, 1
    s_cbranch_scc0 L_tl5
    v_mov_b32 v7, 160768
    v_mov_b32 v8, 0
    v_mov_b32 v9, 0
    ds_write2_b64 v7, v[8:9], v[8:9] offset1:1
    ds_write2_b64 v7, v[8:9], v[8:9] offset0:2 offset1:3
    s_waitcnt vmcnt(7)
    s_barrier
    s_mov_b32 s69, 3
L_tl6:
    s_mov_b32 m0, s14
    s_add_u32 s14, s14, 8192
    buffer_load_dwordx4 v5, s[44:47], m0 offen lds
    s_cmp_ge_u32 s14, s65
    s_cselect_b32 s71, s15, 0
    s_sub_u32 s14, s14, s71
    s_sub_u32 s69, s69, 1
    s_cbranch_scc0 L_tl6
    s_waitcnt lgkmcnt(0)
    s_barrier
    s_cmp_eq_u32 s3, 4
    s_cselect_b32 s69, 5, 4
L_tl7:
    s_mov_b32 m0, s14
    s_add_u32 s14, s14, 8192
    buffer_load_dwordx4 v5, s[44:47], m0 offen lds
    s_cmp_ge_u32 s14, s65
    s_cselect_b32 s71, s15, 0
    s_sub_u32 s14, s14, s71
    s_sub_u32 s69, s69, 1
    s_cbranch_scc0 L_tl7
    s_branch L_help_b
L_aux0:
    s_cmp_gt_u32 s5, 26
    s_cbranch_scc1 L_prefetch
    s_getpc_b64 s[40:41]
L_pc:
    s_sub_u32 s40, s40, L_pc-standalone__deep_cross_xdeepfm__recsys_kernel
    s_subb_u32 s41, s41, 0
    s_mov_b32 s42, L_end-standalone__deep_cross_xdeepfm__recsys_kernel
    s_mov_b32 s43, 0x20000
    v_lshlrev_b32 v3, 7, v0
    buffer_load_dword v255, v3, s[40:43], 0 offen
L_aux:
    s_mov_b32 s67, s4
    s_cmp_lt_u32 s67, 7
    s_cbranch_scc1 L_fold
L_prefetch:
    s_waitcnt lgkmcnt(0)
    s_cmp_lg_u32 s5, 31
    s_cbranch_scc1 L_pf2
    s_mov_b32 s56, s26
    s_mov_b32 s57, s27
    s_mov_b32 s58, 3328
    s_mov_b32 s59, 0x20000
    s_mov_b32 s60, s28
    s_mov_b32 s61, s29
    s_mov_b32 s62, 3328
    s_mov_b32 s63, 0x20000
    s_mov_b32 s52, s36
    s_mov_b32 s53, s37
    s_mov_b32 s54, 335872
    s_mov_b32 s55, 0x20000
    v_lshlrev_b32 v3, 7, v0
    buffer_load_dword v12, v3, s[56:59], 0 offen
    buffer_load_dword v13, v3, s[60:63], 0 offen
    s_mov_b32 s66, 327680
    buffer_load_dword v14, v3, s[52:55], s66 offen
L_pf2:
    s_mov_b32 s48, s24
    s_mov_b32 s49, s25
    s_mov_b32 s50, 5537792
    s_mov_b32 s51, 0x20000
    s_cmp_lt_u32 s4, 7
    s_cselect_b32 s68, 27, 26
    s_sub_u32 s66, s5, s68
    s_sub_u32 s68, 32, s68
    s_mul_i32 s67, s4, 26
    s_lshr_b32 s67, s67, 3
    s_lshl_b32 s67, s67, 7
    v_add_u32 v3, 0, v0
    v_mul_u32_u24 v3, s68, v3
    v_add_u32 v3, s66, v3
    v_lshrrev_b32 v4, 2, v3
    v_add_u32 v4, 128, v4
    v_and_b32 v3, 3, v3
    v_mul_u32_u24 v4, 3328, v4
    v_lshl_add_u32 v3, v3, 7, v4
    buffer_load_dword v9, v3, s[48:51], s67 offen
    s_barrier
    v_add_u32 v3, 512, v0
    v_mul_u32_u24 v3, s68, v3
    v_add_u32 v3, s66, v3
    v_lshrrev_b32 v4, 2, v3
    v_add_u32 v4, 128, v4
    v_and_b32 v3, 3, v3
    v_mul_u32_u24 v4, 3328, v4
    v_lshl_add_u32 v3, v3, 7, v4
    buffer_load_dword v10, v3, s[48:51], s67 offen
    s_barrier
    v_add_u32 v3, 1024, v0
    v_mul_u32_u24 v3, s68, v3
    v_add_u32 v3, s66, v3
    v_lshrrev_b32 v4, 2, v3
    v_add_u32 v4, 128, v4
    v_and_b32 v3, 3, v3
    v_mul_u32_u24 v4, 3328, v4
    v_lshl_add_u32 v3, v3, 7, v4
    buffer_load_dword v11, v3, s[48:51], s67 offen
    s_branch L_aux_done
L_fold:
    s_and_b32 s66, s3, 3
    s_lshl2_add_u32 s6, s67, s66
    v_lshlrev_b32 v3, 2, v0
    v_mov_b32 v7, 0x7fff0000
    s_movk_i32 s67, 338
    v_cmp_gt_u32 vcc, s67, v0
    v_lshrrev_b32 v4, 1, v2
    v_and_b32 v5, 1, v2
    v_cndmask_b32 v3, v7, v3, vcc
    v_lshlrev_b32 v4, 3, v4
    s_waitcnt lgkmcnt(0)
    s_load_dwordx8 s[76:83], s[22:23], 104
    s_load_dwordx4 s[84:87], s[22:23], 136
    s_load_dword s88, s[22:23], 152
    s_mov_b32 s48, s20
    s_mov_b32 s49, s21
    s_mov_b32 s50, 105456
    s_mov_b32 s51, 0x20000
    s_mov_b32 s68, 70304
    buffer_load_dword v16, v3, s[48:51], s68 offen offset:0
    buffer_load_dword v17, v3, s[48:51], s68 offen offset:1352
    buffer_load_dword v18, v3, s[48:51], s68 offen offset:2704
    s_mov_b32 s68, 74360
    buffer_load_dword v19, v3, s[48:51], s68 offen offset:0
    buffer_load_dword v20, v3, s[48:51], s68 offen offset:1352
    buffer_load_dword v21, v3, s[48:51], s68 offen offset:2704
    s_mov_b32 s68, 78416
    buffer_load_dword v22, v3, s[48:51], s68 offen offset:0
    buffer_load_dword v23, v3, s[48:51], s68 offen offset:1352
    buffer_load_dword v24, v3, s[48:51], s68 offen offset:2704
    s_mov_b32 s68, 82472
    buffer_load_dword v25, v3, s[48:51], s68 offen offset:0
    buffer_load_dword v26, v3, s[48:51], s68 offen offset:1352
    buffer_load_dword v27, v3, s[48:51], s68 offen offset:2704
    s_mov_b32 s68, 86528
    buffer_load_dword v28, v3, s[48:51], s68 offen offset:0
    buffer_load_dword v29, v3, s[48:51], s68 offen offset:1352
    buffer_load_dword v30, v3, s[48:51], s68 offen offset:2704
    s_mov_b32 s68, 90584
    buffer_load_dword v31, v3, s[48:51], s68 offen offset:0
    buffer_load_dword v32, v3, s[48:51], s68 offen offset:1352
    buffer_load_dword v33, v3, s[48:51], s68 offen offset:2704
    s_mov_b32 s68, 94640
    buffer_load_dword v34, v3, s[48:51], s68 offen offset:0
    buffer_load_dword v35, v3, s[48:51], s68 offen offset:1352
    buffer_load_dword v36, v3, s[48:51], s68 offen offset:2704
    s_mov_b32 s68, 98696
    buffer_load_dword v37, v3, s[48:51], s68 offen offset:0
    buffer_load_dword v38, v3, s[48:51], s68 offen offset:1352
    buffer_load_dword v39, v3, s[48:51], s68 offen offset:2704
    s_mov_b32 s68, 102752
    buffer_load_dword v40, v3, s[48:51], s68 offen offset:0
    buffer_load_dword v41, v3, s[48:51], s68 offen offset:1352
    s_branch L_fold_b
L_dnn_b:
    v_lshl_add_u32 v6, v4, 3, s73
    v_mov_b32 v7, 160768
    s_mov_b32 s56, s26
    s_mov_b32 s57, s27
    s_mov_b32 s58, 3328
    s_mov_b32 s59, 0x20000
    v_and_b32 v13, 15, v2
    v_mul_u32_u24 v13, 104, v13
    s_lshl2_add_u32 s71, s68, 132096
    v_add_u32 v13, s71, v13
    v_xor_b32 v9, s3, v4
    v_lshl_add_u32 v24, v9, 13, v13
    v_add_u32 v25, 1664, v24
    v_bfe_u32 v9, v2, 2, 2
    v_lshlrev_b32 v13, 7, v9
    v_lshl_add_u32 v13, v4, 10, v13
    v_lshrrev_b32 v9, 1, v9
    v_lshl_add_u32 v13, v9, 5, v13
    v_and_b32 v9, 1, v4
    v_lshl_add_u32 v13, v9, 6, v13
    v_and_b32 v9, 3, v2
    v_lshl_add_u32 v13, v9, 3, v13
    v_add_u32 v106, s64, v13
    v_xor_b32 v107, 32, v106
    v_xor_b32 v108, 64, v106
    v_xor_b32 v109, 0x60, v106
    v_add_u32 v126, s67, v4
    v_lshl_or_b32 v126, v126, 16, v126
    s_mov_b32 s72, 0x00070007
    s_waitcnt vmcnt(8)
    s_barrier
    ds_read2_b32 v[160:161], v24 offset0:0 offset1:2
    ds_read2_b32 v[174:175], v25 offset0:0 offset1:2
    ds_read2_b32 v[162:163], v24 offset0:4 offset1:6
    ds_read2_b32 v[176:177], v25 offset0:4 offset1:6
    ds_read2_b32 v[164:165], v24 offset0:8 offset1:10
    ds_read2_b32 v[178:179], v25 offset0:8 offset1:10
    ds_read2_b32 v[166:167], v24 offset0:12 offset1:14
    ds_read2_b32 v[180:181], v25 offset0:12 offset1:14
    ds_read2_b32 v[168:169], v24 offset0:16 offset1:18
    ds_read2_b32 v[182:183], v25 offset0:16 offset1:18
    ds_read2_b32 v[170:171], v24 offset0:20 offset1:22
    ds_read2_b32 v[184:185], v25 offset0:20 offset1:22
    ds_read2_b32 v[172:173], v24 offset0:24 offset1:26
    ds_read2_b32 v[186:187], v25 offset0:24 offset1:26
    s_mov_b32 s69, 3
L_tl2:
    s_mov_b32 m0, s14
    s_add_u32 s14, s14, 8192
    buffer_load_dwordx4 v5, s[44:47], m0 offen lds
    s_cmp_ge_u32 s14, s65
    s_cselect_b32 s71, s15, 0
    s_sub_u32 s14, s14, s71
    s_sub_u32 s69, s69, 1
    s_cbranch_scc0 L_tl2
    s_mov_b32 s52, s36
    s_mov_b32 s53, s37
    s_mov_b32 s54, 2097152
    s_mov_b32 s55, 0x20000
    s_mov_b32 s60, s28
    s_mov_b32 s61, s29
    s_mov_b32 s62, 3328
    s_mov_b32 s63, 0x20000
    s_waitcnt lgkmcnt(0)
    s_barrier
    s_mov_b32 s69, 3
L_tl3:
    s_mov_b32 m0, s14
    s_add_u32 s14, s14, 8192
    buffer_load_dwordx4 v5, s[44:47], m0 offen lds
    s_cmp_ge_u32 s14, s65
    s_cselect_b32 s71, s15, 0
    s_sub_u32 s14, s14, s71
    s_sub_u32 s69, s69, 1
    s_cbranch_scc0 L_tl3
    v_lshl_or_b32 v80, v174, 16, v160
    v_lshrrev_b32 v13, 1, v80
    v_and_b32 v13, s72, v13
    v_lshl_or_b32 v80, v80, 3, v13
    v_mov_b32 v81, v80
    v_lshl_or_b32 v82, v175, 16, v161
    v_lshrrev_b32 v13, 1, v82
    v_and_b32 v13, s72, v13
    v_lshl_or_b32 v82, v82, 3, v13
    v_mov_b32 v83, v82
    v_permlane32_swap_b32 v80, v81
    v_lshl_or_b32 v84, v176, 16, v162
    v_lshrrev_b32 v13, 1, v84
    v_and_b32 v13, s72, v13
    v_lshl_or_b32 v84, v84, 3, v13
    v_mov_b32 v85, v84
    v_permlane32_swap_b32 v82, v83
    v_lshl_or_b32 v86, v177, 16, v163
    v_lshrrev_b32 v13, 1, v86
    v_and_b32 v13, s72, v13
    v_lshl_or_b32 v86, v86, 3, v13
    v_mov_b32 v87, v86
    v_permlane32_swap_b32 v84, v85
    v_lshl_or_b32 v88, v178, 16, v164
    v_lshrrev_b32 v13, 1, v88
    v_and_b32 v13, s72, v13
    v_lshl_or_b32 v88, v88, 3, v13
    v_mov_b32 v89, v88
    v_permlane32_swap_b32 v86, v87
    v_lshl_or_b32 v90, v179, 16, v165
    v_lshrrev_b32 v13, 1, v90
    v_and_b32 v13, s72, v13
    v_lshl_or_b32 v90, v90, 3, v13
    v_mov_b32 v91, v90
    v_permlane32_swap_b32 v88, v89
    s_mov_b32 s69, 3
L_tl4:
    s_mov_b32 m0, s14
    s_add_u32 s14, s14, 8192
    buffer_load_dwordx4 v5, s[44:47], m0 offen lds
    s_cmp_ge_u32 s14, s65
    s_cselect_b32 s71, s15, 0
    s_sub_u32 s14, s14, s71
    s_sub_u32 s69, s69, 1
    s_cbranch_scc0 L_tl4
    v_lshl_or_b32 v92, v180, 16, v166
    v_lshrrev_b32 v13, 1, v92
    v_and_b32 v13, s72, v13
    v_lshl_or_b32 v92, v92, 3, v13
    v_mov_b32 v93, v92
    v_permlane32_swap_b32 v90, v91
    v_lshl_or_b32 v94, v181, 16, v167
    v_lshrrev_b32 v13, 1, v94
    v_and_b32 v13, s72, v13
    v_lshl_or_b32 v94, v94, 3, v13
    v_mov_b32 v95, v94
    v_permlane32_swap_b32 v92, v93
    v_lshl_or_b32 v96, v182, 16, v168
    v_lshrrev_b32 v13, 1, v96
    v_and_b32 v13, s72, v13
    v_lshl_or_b32 v96, v96, 3, v13
    v_mov_b32 v97, v96
    v_permlane32_swap_b32 v94, v95
    v_lshl_or_b32 v98, v183, 16, v169
    v_lshrrev_b32 v13, 1, v98
    v_and_b32 v13, s72, v13
    v_lshl_or_b32 v98, v98, 3, v13
    v_mov_b32 v99, v98
    v_permlane32_swap_b32 v96, v97
    v_lshl_or_b32 v100, v184, 16, v170
    v_lshrrev_b32 v13, 1, v100
    v_and_b32 v13, s72, v13
    v_lshl_or_b32 v100, v100, 3, v13
    v_mov_b32 v101, v100
    v_permlane32_swap_b32 v98, v99
    v_lshl_or_b32 v102, v185, 16, v171
    v_lshrrev_b32 v13, 1, v102
    v_and_b32 v13, s72, v13
    v_lshl_or_b32 v102, v102, 3, v13
    v_mov_b32 v103, v102
    v_permlane32_swap_b32 v100, v101
    v_lshl_or_b32 v104, v186, 16, v172
    v_lshrrev_b32 v13, 1, v104
    v_and_b32 v13, s72, v13
    v_lshl_or_b32 v104, v104, 3, v13
    v_mov_b32 v105, v104
    v_permlane32_swap_b32 v102, v103
    s_nop 1
    v_permlane32_swap_b32 v104, v105
    v_mov_b32 v110, v80
    v_mov_b32 v111, v81
    s_nop 0
    v_permlane16_swap_b32 v80, v110
    v_xor_b32 v80, v126, v80
    v_xor_b32 v110, v126, v110
    v_permlane16_swap_b32 v81, v111
    v_xor_b32 v81, v126, v81
    v_xor_b32 v111, v126, v111
    v_lshlrev_b32_sdwa v8, 4, v80 dst_sel:DWORD dst_unused:UNUSED_PAD src0_sel:DWORD src1_sel:WORD_0
    v_lshlrev_b32_sdwa v9, 4, v80 dst_sel:DWORD dst_unused:UNUSED_PAD src0_sel:DWORD src1_sel:WORD_1
    v_lshlrev_b32_sdwa v10, 4, v110 dst_sel:DWORD dst_unused:UNUSED_PAD src0_sel:DWORD src1_sel:WORD_0
    v_lshlrev_b32_sdwa v11, 4, v110 dst_sel:DWORD dst_unused:UNUSED_PAD src0_sel:DWORD src1_sel:WORD_1
    v_lshlrev_b32_sdwa v12, 4, v81 dst_sel:DWORD dst_unused:UNUSED_PAD src0_sel:DWORD src1_sel:WORD_0
    v_lshlrev_b32_sdwa v13, 4, v81 dst_sel:DWORD dst_unused:UNUSED_PAD src0_sel:DWORD src1_sel:WORD_1
    v_lshlrev_b32_sdwa v14, 4, v111 dst_sel:DWORD dst_unused:UNUSED_PAD src0_sel:DWORD src1_sel:WORD_0
    v_lshlrev_b32_sdwa v15, 4, v111 dst_sel:DWORD dst_unused:UNUSED_PAD src0_sel:DWORD src1_sel:WORD_1
    v_mov_b32 v110, v82
    s_waitcnt vmcnt(12)
    ds_read_b64_tr_b16 v[48:49], v106 offset:0
    ds_read_b64_tr_b16 v[50:51], v106 offset:512
    ds_read_b64_tr_b16 v[52:53], v107 offset:0
    ds_read_b64_tr_b16 v[54:55], v107 offset:512
    ds_read_b64_tr_b16 v[56:57], v108 offset:0
    ds_read_b64_tr_b16 v[58:59], v108 offset:512
    ds_read_b64_tr_b16 v[60:61], v109 offset:0
    ds_read_b64_tr_b16 v[62:63], v109 offset:512
    v_permlane16_swap_b32 v82, v110
    v_xor_b32 v82, v126, v82
    v_xor_b32 v110, v126, v110
    s_add_u32 m0, s64, 4096
    s_mov_b32 s12, 425984
    buffer_load_dwordx4 v1, s[48:51], s12 offen offset:0 lds
    buffer_load_dwordx4 v3, s[48:51], s12 offen offset:1024 lds
    s_add_u32 m0, s64, 6144
    s_mov_b32 s12, 479232
    buffer_load_dwordx4 v1, s[48:51], s12 offen offset:0 lds
    buffer_load_dwordx4 v3, s[48:51], s12 offen offset:1024 lds
    s_waitcnt lgkmcnt(0)
    s_xor_b32 s66, s3, 1
    s_lshl_b32 s66, s66, 12
    v_lshlrev_b32 v5, 4, v2
    v_add_u32 v123, s66, v5
    v_xor_b32 v124, 12288, v123
    v_xor_b32 v125, 8192, v123
    s_lshl_b32 s66, s3, 12
    v_add_u32 v5, s66, v5
    v_lshrrev_b32 v122, 5, v2
    v_and_b32 v0, 15, v2
    v_lshl_add_u32 v122, v122, 4, v0
    s_lshl_b32 s66, s8, 7
    s_lshl_b32 s67, s3, 5
    s_add_u32 s66, s66, s67
    v_add_lshl_u32 v122, v122, s66, 3
    s_waitcnt vmcnt(4)
    s_barrier
    s_setprio 1
    ds_read_b128 v[24:27], v10
    ds_read_b128 v[28:31], v11
    ds_read_b128 v[32:35], v12
    ds_read_b128 v[36:39], v13
    ds_read_b128 v[40:43], v14
    ds_read_b128 v[44:47], v15
    ds_read_b128 v[16:19], v8
    ds_read_b128 v[20:23], v9
    s_waitcnt lgkmcnt(6)
    v_mfma_f32_16x16x32_bf16 v[160:163], v[48:51], v[24:27], 0
    s_add_u32 m0, s64, 0
    v_mfma_f32_16x16x32_bf16 v[164:167], v[52:55], v[24:27], 0
    s_mov_b32 s12, 851968
    v_mfma_f32_16x16x32_bf16 v[168:171], v[56:59], v[24:27], 0
    v_lshlrev_b32_sdwa v10, 4, v110 dst_sel:DWORD dst_unused:UNUSED_PAD src0_sel:DWORD src1_sel:WORD_0
    v_mov_b32 v111, v83
    v_mfma_f32_16x16x32_bf16 v[172:175], v[60:63], v[24:27], 0
    ds_read_b128 v[24:27], v10
    v_mfma_f32_16x16x32_bf16 v[176:179], v[48:51], v[28:31], 0
    buffer_load_dwordx4 v1, s[48:51], s12 offen offset:0 lds
    v_mfma_f32_16x16x32_bf16 v[180:183], v[52:55], v[28:31], 0
    buffer_load_dwordx4 v3, s[48:51], s12 offen offset:1024 lds
    v_mfma_f32_16x16x32_bf16 v[184:187], v[56:59], v[28:31], 0
    v_lshlrev_b32_sdwa v11, 4, v110 dst_sel:DWORD dst_unused:UNUSED_PAD src0_sel:DWORD src1_sel:WORD_1
    v_permlane16_swap_b32 v83, v111
    v_mfma_f32_16x16x32_bf16 v[188:191], v[60:63], v[28:31], 0
    ds_read_b128 v[28:31], v11
    v_xor_b32 v83, v126, v83
    s_waitcnt lgkmcnt(6)
    v_mfma_f32_16x16x32_bf16 v[192:195], v[48:51], v[32:35], 0
    s_add_u32 m0, s64, 2048
    v_mfma_f32_16x16x32_bf16 v[196:199], v[52:55], v[32:35], 0
    s_mov_b32 s12, 905216
    v_mfma_f32_16x16x32_bf16 v[200:203], v[56:59], v[32:35], 0
    v_lshlrev_b32_sdwa v12, 4, v83 dst_sel:DWORD dst_unused:UNUSED_PAD src0_sel:DWORD src1_sel:WORD_0
    v_mfma_f32_16x16x32_bf16 v[204:207], v[60:63], v[32:35], 0
    ds_read_b128 v[32:35], v12
    v_xor_b32 v111, v126, v111
    v_mfma_f32_16x16x32_bf16 v[208:211], v[48:51], v[36:39], 0
    buffer_load_dwordx4 v1, s[48:51], s12 offen offset:0 lds
    v_mfma_f32_16x16x32_bf16 v[212:215], v[52:55], v[36:39], 0
    buffer_load_dwordx4 v3, s[48:51], s12 offen offset:1024 lds
    v_mfma_f32_16x16x32_bf16 v[216:219], v[56:59], v[36:39], 0
    v_lshlrev_b32_sdwa v13, 4, v83 dst_sel:DWORD dst_unused:UNUSED_PAD src0_sel:DWORD src1_sel:WORD_1
    v_mfma_f32_16x16x32_bf16 v[220:223], v[60:63], v[36:39], 0
    ds_read_b128 v[36:39], v13
    s_waitcnt lgkmcnt(6)
    v_mfma_f32_16x16x32_bf16 v[224:227], v[48:51], v[40:43], 0
    s_waitcnt vmcnt(4)
    ds_read_b64_tr_b16 v[64:65], v106 offset:4096
    v_mfma_f32_16x16x32_bf16 v[228:231], v[52:55], v[40:43], 0
    ds_read_b64_tr_b16 v[66:67], v106 offset:4608
    v_mfma_f32_16x16x32_bf16 v[232:235], v[56:59], v[40:43], 0
    v_lshlrev_b32_sdwa v14, 4, v111 dst_sel:DWORD dst_unused:UNUSED_PAD src0_sel:DWORD src1_sel:WORD_0
    v_mfma_f32_16x16x32_bf16 v[236:239], v[60:63], v[40:43], 0
    ds_read_b128 v[40:43], v14
    v_mfma_f32_16x16x32_bf16 v[240:243], v[48:51], v[44:47], 0
    ds_read_b64_tr_b16 v[68:69], v107 offset:4096
    v_mfma_f32_16x16x32_bf16 v[244:247], v[52:55], v[44:47], 0
    ds_read_b64_tr_b16 v[70:71], v107 offset:4608
    v_mfma_f32_16x16x32_bf16 v[248:251], v[56:59], v[44:47], 0
    v_lshlrev_b32_sdwa v15, 4, v111 dst_sel:DWORD dst_unused:UNUSED_PAD src0_sel:DWORD src1_sel:WORD_1
    v_mfma_f32_16x16x32_bf16 v[252:255], v[60:63], v[44:47], 0
    ds_read_b128 v[44:47], v15
    v_mov_b32 v110, v84
    s_waitcnt lgkmcnt(10)
    v_mfma_f32_16x16x32_bf16 v[128:131], v[48:51], v[16:19], 0
    ds_read_b64_tr_b16 v[72:73], v108 offset:4096
    v_mfma_f32_16x16x32_bf16 v[132:135], v[52:55], v[16:19], 0
    ds_read_b64_tr_b16 v[74:75], v108 offset:4608
    v_mfma_f32_16x16x32_bf16 v[136:139], v[56:59], v[16:19], 0
    v_lshlrev_b32_sdwa v8, 4, v82 dst_sel:DWORD dst_unused:UNUSED_PAD src0_sel:DWORD src1_sel:WORD_0
    v_permlane16_swap_b32 v84, v110
    v_mfma_f32_16x16x32_bf16 v[140:143], v[60:63], v[16:19], 0
    ds_read_b128 v[16:19], v8
    v_xor_b32 v84, v126, v84
    v_mfma_f32_16x16x32_bf16 v[144:147], v[48:51], v[20:23], 0
    ds_read_b64_tr_b16 v[76:77], v109 offset:4096
    v_mfma_f32_16x16x32_bf16 v[148:151], v[52:55], v[20:23], 0
    ds_read_b64_tr_b16 v[78:79], v109 offset:4608
    v_mfma_f32_16x16x32_bf16 v[152:155], v[56:59], v[20:23], 0
    v_lshlrev_b32_sdwa v9, 4, v82 dst_sel:DWORD dst_unused:UNUSED_PAD src0_sel:DWORD src1_sel:WORD_1
    v_xor_b32 v110, v126, v110
    v_mfma_f32_16x16x32_bf16 v[156:159], v[60:63], v[20:23], 0
    ds_read_b128 v[20:23], v9
    s_waitcnt lgkmcnt(1)
    v_mfma_f32_16x16x32_bf16 v[160:163], v[64:67], v[24:27], v[160:163]
    s_waitcnt vmcnt(0)
    ds_read_b64_tr_b16 v[48:49], v106 offset:0
    v_mfma_f32_16x16x32_bf16 v[164:167], v[68:71], v[24:27], v[164:167]
    ds_read_b64_tr_b16 v[50:51], v106 offset:512
    v_mfma_f32_16x16x32_bf16 v[168:171], v[72:75], v[24:27], v[168:171]
    v_lshlrev_b32_sdwa v10, 4, v110 dst_sel:DWORD dst_unused:UNUSED_PAD src0_sel:DWORD src1_sel:WORD_0
    v_mov_b32 v111, v85
    v_mfma_f32_16x16x32_bf16 v[172:175], v[76:79], v[24:27], v[172:175]
    ds_read_b128 v[24:27], v10
    s_add_u32 m0, s64, 4096
    v_mfma_f32_16x16x32_bf16 v[176:179], v[64:67], v[28:31], v[176:179]
    ds_read_b64_tr_b16 v[52:53], v107 offset:0
    v_mfma_f32_16x16x32_bf16 v[180:183], v[68:71], v[28:31], v[180:183]
    ds_read_b64_tr_b16 v[54:55], v107 offset:512
    v_mfma_f32_16x16x32_bf16 v[184:187], v[72:75], v[28:31], v[184:187]
    v_lshlrev_b32_sdwa v11, 4, v110 dst_sel:DWORD dst_unused:UNUSED_PAD src0_sel:DWORD src1_sel:WORD_1
    v_permlane16_swap_b32 v85, v111
    v_mfma_f32_16x16x32_bf16 v[188:191], v[76:79], v[28:31], v[188:191]
    ds_read_b128 v[28:31], v11
    v_xor_b32 v85, v126, v85
    s_mov_b32 s12, 1277952
    v_mfma_f32_16x16x32_bf16 v[192:195], v[64:67], v[32:35], v[192:195]
    ds_read_b64_tr_b16 v[56:57], v108 offset:0
    v_mfma_f32_16x16x32_bf16 v[196:199], v[68:71], v[32:35], v[196:199]
    ds_read_b64_tr_b16 v[58:59], v108 offset:512
    v_mfma_f32_16x16x32_bf16 v[200:203], v[72:75], v[32:35], v[200:203]
    v_lshlrev_b32_sdwa v12, 4, v85 dst_sel:DWORD dst_unused:UNUSED_PAD src0_sel:DWORD src1_sel:WORD_0
    buffer_load_dwordx4 v1, s[48:51], s12 offen offset:0 lds
    v_mfma_f32_16x16x32_bf16 v[204:207], v[76:79], v[32:35], v[204:207]
    ds_read_b128 v[32:35], v12
    v_xor_b32 v111, v126, v111
    buffer_load_dwordx4 v3, s[48:51], s12 offen offset:1024 lds
    v_mfma_f32_16x16x32_bf16 v[208:211], v[64:67], v[36:39], v[208:211]
    ds_read_b64_tr_b16 v[60:61], v109 offset:0
    v_mfma_f32_16x16x32_bf16 v[212:215], v[68:71], v[36:39], v[212:215]
    ds_read_b64_tr_b16 v[62:63], v109 offset:512
    v_mfma_f32_16x16x32_bf16 v[216:219], v[72:75], v[36:39], v[216:219]
    v_lshlrev_b32_sdwa v13, 4, v85 dst_sel:DWORD dst_unused:UNUSED_PAD src0_sel:DWORD src1_sel:WORD_1
    s_add_u32 m0, s64, 6144
    v_mfma_f32_16x16x32_bf16 v[220:223], v[76:79], v[36:39], v[220:223]
    ds_read_b128 v[36:39], v13
    s_mov_b32 s12, 1331200
    v_mfma_f32_16x16x32_bf16 v[224:227], v[64:67], v[40:43], v[224:227]
    v_mfma_f32_16x16x32_bf16 v[228:231], v[68:71], v[40:43], v[228:231]
    v_mfma_f32_16x16x32_bf16 v[232:235], v[72:75], v[40:43], v[232:235]
    v_lshlrev_b32_sdwa v14, 4, v111 dst_sel:DWORD dst_unused:UNUSED_PAD src0_sel:DWORD src1_sel:WORD_0
    buffer_load_dwordx4 v1, s[48:51], s12 offen offset:0 lds
    v_mfma_f32_16x16x32_bf16 v[236:239], v[76:79], v[40:43], v[236:239]
    ds_read_b128 v[40:43], v14
    buffer_load_dwordx4 v3, s[48:51], s12 offen offset:1024 lds
    v_mfma_f32_16x16x32_bf16 v[240:243], v[64:67], v[44:47], v[240:243]
    s_add_u32 m0, s64, 0
    v_mfma_f32_16x16x32_bf16 v[244:247], v[68:71], v[44:47], v[244:247]
    s_mov_b32 s12, 1703936
    v_mfma_f32_16x16x32_bf16 v[248:251], v[72:75], v[44:47], v[248:251]
    v_lshlrev_b32_sdwa v15, 4, v111 dst_sel:DWORD dst_unused:UNUSED_PAD src0_sel:DWORD src1_sel:WORD_1
    s_waitcnt lgkmcnt(2)
    buffer_load_dwordx4 v1, s[48:51], s12 offen offset:0 lds
    v_mfma_f32_16x16x32_bf16 v[252:255], v[76:79], v[44:47], v[252:255]
    ds_read_b128 v[44:47], v15
    v_mov_b32 v110, v86
    v_mfma_f32_16x16x32_bf16 v[128:131], v[64:67], v[16:19], v[128:131]
    buffer_load_dwordx4 v3, s[48:51], s12 offen offset:1024 lds
    v_mfma_f32_16x16x32_bf16 v[132:135], v[68:71], v[16:19], v[132:135]
    s_add_u32 m0, s64, 2048
    v_mfma_f32_16x16x32_bf16 v[136:139], v[72:75], v[16:19], v[136:139]
    v_lshlrev_b32_sdwa v8, 4, v84 dst_sel:DWORD dst_unused:UNUSED_PAD src0_sel:DWORD src1_sel:WORD_0
    v_permlane16_swap_b32 v86, v110
    v_mfma_f32_16x16x32_bf16 v[140:143], v[76:79], v[16:19], v[140:143]
    ds_read_b128 v[16:19], v8
    v_xor_b32 v86, v126, v86
    v_mfma_f32_16x16x32_bf16 v[144:147], v[64:67], v[20:23], v[144:147]
    s_mov_b32 s12, 1757184
    v_mfma_f32_16x16x32_bf16 v[148:151], v[68:71], v[20:23], v[148:151]
    buffer_load_dwordx4 v1, s[48:51], s12 offen offset:0 lds
    v_mfma_f32_16x16x32_bf16 v[152:155], v[72:75], v[20:23], v[152:155]
    v_lshlrev_b32_sdwa v9, 4, v84 dst_sel:DWORD dst_unused:UNUSED_PAD src0_sel:DWORD src1_sel:WORD_1
    v_xor_b32 v110, v126, v110
    v_mfma_f32_16x16x32_bf16 v[156:159], v[76:79], v[20:23], v[156:159]
    ds_read_b128 v[20:23], v9
    buffer_load_dwordx4 v3, s[48:51], s12 offen offset:1024 lds
    v_mfma_f32_16x16x32_bf16 v[160:163], v[48:51], v[24:27], v[160:163]
    s_waitcnt vmcnt(4)
    ds_read_b64_tr_b16 v[64:65], v106 offset:4096
    v_mfma_f32_16x16x32_bf16 v[164:167], v[52:55], v[24:27], v[164:167]
    ds_read_b64_tr_b16 v[66:67], v106 offset:4608
    v_mfma_f32_16x16x32_bf16 v[168:171], v[56:59], v[24:27], v[168:171]
    v_lshlrev_b32_sdwa v10, 4, v110 dst_sel:DWORD dst_unused:UNUSED_PAD src0_sel:DWORD src1_sel:WORD_0
    v_mov_b32 v111, v87
    v_mfma_f32_16x16x32_bf16 v[172:175], v[60:63], v[24:27], v[172:175]
    ds_read_b128 v[24:27], v10
    v_mfma_f32_16x16x32_bf16 v[176:179], v[48:51], v[28:31], v[176:179]
    ds_read_b64_tr_b16 v[68:69], v107 offset:4096
    buffer_load_dwordx2 v[112:113], v6, s[56:59], 0 offen offset:0
    v_mfma_f32_16x16x32_bf16 v[180:183], v[52:55], v[28:31], v[180:183]
    ds_read_b64_tr_b16 v[70:71], v107 offset:4608
    buffer_load_dwordx2 v[114:115], v6, s[56:59], 0 offen offset:32
    v_mfma_f32_16x16x32_bf16 v[184:187], v[56:59], v[28:31], v[184:187]
    v_lshlrev_b32_sdwa v11, 4, v110 dst_sel:DWORD dst_unused:UNUSED_PAD src0_sel:DWORD src1_sel:WORD_1
    v_permlane16_swap_b32 v87, v111
    v_mfma_f32_16x16x32_bf16 v[188:191], v[60:63], v[28:31], v[188:191]
    ds_read_b128 v[28:31], v11
    v_xor_b32 v87, v126, v87
    s_waitcnt lgkmcnt(10)
    v_mfma_f32_16x16x32_bf16 v[192:195], v[48:51], v[32:35], v[192:195]
    ds_read_b64_tr_b16 v[72:73], v108 offset:4096
    buffer_load_dwordx2 v[116:117], v6, s[56:59], 0 offen offset:64
    v_mfma_f32_16x16x32_bf16 v[196:199], v[52:55], v[32:35], v[196:199]
    ds_read_b64_tr_b16 v[74:75], v108 offset:4608
    buffer_load_dwordx2 v[118:119], v6, s[56:59], 0 offen offset:96
    v_mfma_f32_16x16x32_bf16 v[200:203], v[56:59], v[32:35], v[200:203]
    v_lshlrev_b32_sdwa v12, 4, v87 dst_sel:DWORD dst_unused:UNUSED_PAD src0_sel:DWORD src1_sel:WORD_0
    v_mfma_f32_16x16x32_bf16 v[204:207], v[60:63], v[32:35], v[204:207]
    ds_read_b128 v[32:35], v12
    v_xor_b32 v111, v126, v111
    v_mfma_f32_16x16x32_bf16 v[208:211], v[48:51], v[36:39], v[208:211]
    ds_read_b64_tr_b16 v[76:77], v109 offset:4096
    v_mfma_f32_16x16x32_bf16 v[212:215], v[52:55], v[36:39], v[212:215]
    ds_read_b64_tr_b16 v[78:79], v109 offset:4608
    v_mfma_f32_16x16x32_bf16 v[216:219], v[56:59], v[36:39], v[216:219]
    v_lshlrev_b32_sdwa v13, 4, v87 dst_sel:DWORD dst_unused:UNUSED_PAD src0_sel:DWORD src1_sel:WORD_1
    v_mfma_f32_16x16x32_bf16 v[220:223], v[60:63], v[36:39], v[220:223]
    ds_read_b128 v[36:39], v13
    s_waitcnt lgkmcnt(14)
    v_mfma_f32_16x16x32_bf16 v[224:227], v[48:51], v[40:43], v[224:227]
    s_add_u32 m0, s64, 4096
    v_mfma_f32_16x16x32_bf16 v[228:231], v[52:55], v[40:43], v[228:231]
    s_mov_b32 s12, 2129920
    v_mfma_f32_16x16x32_bf16 v[232:235], v[56:59], v[40:43], v[232:235]
    v_lshlrev_b32_sdwa v14, 4, v111 dst_sel:DWORD dst_unused:UNUSED_PAD src0_sel:DWORD src1_sel:WORD_0
    v_mfma_f32_16x16x32_bf16 v[236:239], v[60:63], v[40:43], v[236:239]
    ds_read_b128 v[40:43], v14
    v_mfma_f32_16x16x32_bf16 v[240:243], v[48:51], v[44:47], v[240:243]
    s_waitcnt lgkmcnt(2)
    buffer_load_dwordx4 v1, s[48:51], s12 offen offset:0 lds
    v_mfma_f32_16x16x32_bf16 v[244:247], v[52:55], v[44:47], v[244:247]
    buffer_load_dwordx4 v3, s[48:51], s12 offen offset:1024 lds
    v_mfma_f32_16x16x32_bf16 v[248:251], v[56:59], v[44:47], v[248:251]
    v_lshlrev_b32_sdwa v15, 4, v111 dst_sel:DWORD dst_unused:UNUSED_PAD src0_sel:DWORD src1_sel:WORD_1
    v_mfma_f32_16x16x32_bf16 v[252:255], v[60:63], v[44:47], v[252:255]
    ds_read_b128 v[44:47], v15
    v_mov_b32 v110, v88
    v_mfma_f32_16x16x32_bf16 v[128:131], v[48:51], v[16:19], v[128:131]
    s_add_u32 m0, s64, 6144
    v_mfma_f32_16x16x32_bf16 v[132:135], v[52:55], v[16:19], v[132:135]
    s_mov_b32 s12, 2183168
    v_mfma_f32_16x16x32_bf16 v[136:139], v[56:59], v[16:19], v[136:139]
    v_lshlrev_b32_sdwa v8, 4, v86 dst_sel:DWORD dst_unused:UNUSED_PAD src0_sel:DWORD src1_sel:WORD_0
    v_permlane16_swap_b32 v88, v110
    v_mfma_f32_16x16x32_bf16 v[140:143], v[60:63], v[16:19], v[140:143]
    ds_read_b128 v[16:19], v8
    v_xor_b32 v88, v126, v88
    v_mfma_f32_16x16x32_bf16 v[144:147], v[48:51], v[20:23], v[144:147]
    buffer_load_dwordx4 v1, s[48:51], s12 offen offset:0 lds
    v_mfma_f32_16x16x32_bf16 v[148:151], v[52:55], v[20:23], v[148:151]
    buffer_load_dwordx4 v3, s[48:51], s12 offen offset:1024 lds
    v_mfma_f32_16x16x32_bf16 v[152:155], v[56:59], v[20:23], v[152:155]
    v_lshlrev_b32_sdwa v9, 4, v86 dst_sel:DWORD dst_unused:UNUSED_PAD src0_sel:DWORD src1_sel:WORD_1
    v_xor_b32 v110, v126, v110
    v_mfma_f32_16x16x32_bf16 v[156:159], v[60:63], v[20:23], v[156:159]
    ds_read_b128 v[20:23], v9
    v_mfma_f32_16x16x32_bf16 v[160:163], v[64:67], v[24:27], v[160:163]
    s_waitcnt vmcnt(8)
    ds_read_b64_tr_b16 v[48:49], v106 offset:0
    v_mfma_f32_16x16x32_bf16 v[164:167], v[68:71], v[24:27], v[164:167]
    ds_read_b64_tr_b16 v[50:51], v106 offset:512
    v_mfma_f32_16x16x32_bf16 v[168:171], v[72:75], v[24:27], v[168:171]
    v_lshlrev_b32_sdwa v10, 4, v110 dst_sel:DWORD dst_unused:UNUSED_PAD src0_sel:DWORD src1_sel:WORD_0
    v_mov_b32 v111, v89
    v_mfma_f32_16x16x32_bf16 v[172:175], v[76:79], v[24:27], v[172:175]
    ds_read_b128 v[24:27], v10
    v_mfma_f32_16x16x32_bf16 v[176:179], v[64:67], v[28:31], v[176:179]
    ds_read_b64_tr_b16 v[52:53], v107 offset:0
    v_mfma_f32_16x16x32_bf16 v[180:183], v[68:71], v[28:31], v[180:183]
    ds_read_b64_tr_b16 v[54:55], v107 offset:512
    s_waitcnt vmcnt(4)
    v_mfma_f32_16x16x32_bf16 v[184:187], v[72:75], v[28:31], v[184:187]
    v_lshlrev_b32_sdwa v11, 4, v110 dst_sel:DWORD dst_unused:UNUSED_PAD src0_sel:DWORD src1_sel:WORD_1
    v_permlane16_swap_b32 v89, v111
    v_mfma_f32_16x16x32_bf16 v[188:191], v[76:79], v[28:31], v[188:191]
    ds_read_b128 v[28:31], v11
    v_xor_b32 v89, v126, v89
    s_waitcnt lgkmcnt(10)
    v_mfma_f32_16x16x32_bf16 v[192:195], v[64:67], v[32:35], v[192:195]
    ds_read_b64_tr_b16 v[56:57], v108 offset:0
    v_lshlrev_b32 v0, 16, v112
    v_mfma_f32_16x16x32_bf16 v[196:199], v[68:71], v[32:35], v[196:199]
    ds_read_b64_tr_b16 v[58:59], v108 offset:512
    v_add_f32 v128, v128, v0
    v_mfma_f32_16x16x32_bf16 v[200:203], v[72:75], v[32:35], v[200:203]
    v_lshlrev_b32_sdwa v12, 4, v89 dst_sel:DWORD dst_unused:UNUSED_PAD src0_sel:DWORD src1_sel:WORD_0
    v_add_f32 v144, v144, v0
    v_mfma_f32_16x16x32_bf16 v[204:207], v[76:79], v[32:35], v[204:207]
    ds_read_b128 v[32:35], v12
    v_xor_b32 v111, v126, v111
    v_mfma_f32_16x16x32_bf16 v[208:211], v[64:67], v[36:39], v[208:211]
    ds_read_b64_tr_b16 v[60:61], v109 offset:0
    v_and_b32 v0, 0xffff0000, v112
    v_mfma_f32_16x16x32_bf16 v[212:215], v[68:71], v[36:39], v[212:215]
    ds_read_b64_tr_b16 v[62:63], v109 offset:512
    v_add_f32 v129, v129, v0
    v_mfma_f32_16x16x32_bf16 v[216:219], v[72:75], v[36:39], v[216:219]
    v_lshlrev_b32_sdwa v13, 4, v89 dst_sel:DWORD dst_unused:UNUSED_PAD src0_sel:DWORD src1_sel:WORD_1
    v_add_f32 v145, v145, v0
    v_mfma_f32_16x16x32_bf16 v[220:223], v[76:79], v[36:39], v[220:223]
    ds_read_b128 v[36:39], v13
    s_waitcnt lgkmcnt(14)
    v_mfma_f32_16x16x32_bf16 v[224:227], v[64:67], v[40:43], v[224:227]
    s_add_u32 m0, s64, 0
    v_mfma_f32_16x16x32_bf16 v[228:231], v[68:71], v[40:43], v[228:231]
    s_mov_b32 s12, 2555904
    v_mfma_f32_16x16x32_bf16 v[232:235], v[72:75], v[40:43], v[232:235]
    v_lshlrev_b32_sdwa v14, 4, v111 dst_sel:DWORD dst_unused:UNUSED_PAD src0_sel:DWORD src1_sel:WORD_0
    v_mfma_f32_16x16x32_bf16 v[236:239], v[76:79], v[40:43], v[236:239]
    ds_read_b128 v[40:43], v14
    v_mfma_f32_16x16x32_bf16 v[240:243], v[64:67], v[44:47], v[240:243]
    s_waitcnt lgkmcnt(2)
    buffer_load_dwordx4 v1, s[48:51], s12 offen offset:0 lds
    v_mfma_f32_16x16x32_bf16 v[244:247], v[68:71], v[44:47], v[244:247]
    buffer_load_dwordx4 v3, s[48:51], s12 offen offset:1024 lds
    v_mfma_f32_16x16x32_bf16 v[248:251], v[72:75], v[44:47], v[248:251]
    v_lshlrev_b32_sdwa v15, 4, v111 dst_sel:DWORD dst_unused:UNUSED_PAD src0_sel:DWORD src1_sel:WORD_1
    v_mfma_f32_16x16x32_bf16 v[252:255], v[76:79], v[44:47], v[252:255]
    ds_read_b128 v[44:47], v15
    v_mov_b32 v110, v90
    v_mfma_f32_16x16x32_bf16 v[128:131], v[64:67], v[16:19], v[128:131]
    s_add_u32 m0, s64, 2048
    v_mfma_f32_16x16x32_bf16 v[132:135], v[68:71], v[16:19], v[132:135]
    s_mov_b32 s12, 2609152
    v_mfma_f32_16x16x32_bf16 v[136:139], v[72:75], v[16:19], v[136:139]
    v_lshlrev_b32_sdwa v8, 4, v88 dst_sel:DWORD dst_unused:UNUSED_PAD src0_sel:DWORD src1_sel:WORD_0
    v_permlane16_swap_b32 v90, v110
    v_mfma_f32_16x16x32_bf16 v[140:143], v[76:79], v[16:19], v[140:143]
    ds_read_b128 v[16:19], v8
    v_xor_b32 v90, v126, v90
    v_mfma_f32_16x16x32_bf16 v[144:147], v[64:67], v[20:23], v[144:147]
    buffer_load_dwordx4 v1, s[48:51], s12 offen offset:0 lds
    v_mfma_f32_16x16x32_bf16 v[148:151], v[68:71], v[20:23], v[148:151]
    buffer_load_dwordx4 v3, s[48:51], s12 offen offset:1024 lds
    v_mfma_f32_16x16x32_bf16 v[152:155], v[72:75], v[20:23], v[152:155]
    v_lshlrev_b32_sdwa v9, 4, v88 dst_sel:DWORD dst_unused:UNUSED_PAD src0_sel:DWORD src1_sel:WORD_1
    v_xor_b32 v110, v126, v110
    v_mfma_f32_16x16x32_bf16 v[156:159], v[76:79], v[20:23], v[156:159]
    ds_read_b128 v[20:23], v9
    v_mfma_f32_16x16x32_bf16 v[160:163], v[48:51], v[24:27], v[160:163]
    s_waitcnt vmcnt(4)
    ds_read_b64_tr_b16 v[64:65], v106 offset:4096
    v_mfma_f32_16x16x32_bf16 v[164:167], v[52:55], v[24:27], v[164:167]
    ds_read_b64_tr_b16 v[66:67], v106 offset:4608
    v_mfma_f32_16x16x32_bf16 v[168:171], v[56:59], v[24:27], v[168:171]
    v_lshlrev_b32_sdwa v10, 4, v110 dst_sel:DWORD dst_unused:UNUSED_PAD src0_sel:DWORD src1_sel:WORD_0
    v_mov_b32 v111, v91
    v_mfma_f32_16x16x32_bf16 v[172:175], v[60:63], v[24:27], v[172:175]
    ds_read_b128 v[24:27], v10
    v_mfma_f32_16x16x32_bf16 v[176:179], v[48:51], v[28:31], v[176:179]
    ds_read_b64_tr_b16 v[68:69], v107 offset:4096
    v_mfma_f32_16x16x32_bf16 v[180:183], v[52:55], v[28:31], v[180:183]
    ds_read_b64_tr_b16 v[70:71], v107 offset:4608
    v_lshlrev_b32 v0, 16, v113
    v_mfma_f32_16x16x32_bf16 v[184:187], v[56:59], v[28:31], v[184:187]
    v_lshlrev_b32_sdwa v11, 4, v110 dst_sel:DWORD dst_unused:UNUSED_PAD src0_sel:DWORD src1_sel:WORD_1
    v_permlane16_swap_b32 v91, v111
    v_mfma_f32_16x16x32_bf16 v[188:191], v[60:63], v[28:31], v[188:191]
    ds_read_b128 v[28:31], v11
    v_xor_b32 v91, v126, v91
    s_waitcnt lgkmcnt(10)
    v_mfma_f32_16x16x32_bf16 v[192:195], v[48:51], v[32:35], v[192:195]
    ds_read_b64_tr_b16 v[72:73], v108 offset:4096
    v_add_f32 v130, v130, v0
    v_mfma_f32_16x16x32_bf16 v[196:199], v[52:55], v[32:35], v[196:199]
    ds_read_b64_tr_b16 v[74:75], v108 offset:4608
    v_add_f32 v146, v146, v0
    v_mfma_f32_16x16x32_bf16 v[200:203], v[56:59], v[32:35], v[200:203]
    v_lshlrev_b32_sdwa v12, 4, v91 dst_sel:DWORD dst_unused:UNUSED_PAD src0_sel:DWORD src1_sel:WORD_0
    v_and_b32 v0, 0xffff0000, v113
    v_mfma_f32_16x16x32_bf16 v[204:207], v[60:63], v[32:35], v[204:207]
    ds_read_b128 v[32:35], v12
    v_xor_b32 v111, v126, v111
    v_mfma_f32_16x16x32_bf16 v[208:211], v[48:51], v[36:39], v[208:211]
    ds_read_b64_tr_b16 v[76:77], v109 offset:4096
    v_add_f32 v131, v131, v0
    v_mfma_f32_16x16x32_bf16 v[212:215], v[52:55], v[36:39], v[212:215]
    ds_read_b64_tr_b16 v[78:79], v109 offset:4608
    v_add_f32 v147, v147, v0
    v_mfma_f32_16x16x32_bf16 v[216:219], v[56:59], v[36:39], v[216:219]
    v_lshlrev_b32_sdwa v13, 4, v91 dst_sel:DWORD dst_unused:UNUSED_PAD src0_sel:DWORD src1_sel:WORD_1
    v_lshlrev_b32 v0, 16, v114
    v_mfma_f32_16x16x32_bf16 v[220:223], v[60:63], v[36:39], v[220:223]
    ds_read_b128 v[36:39], v13
    v_add_f32 v132, v132, v0
    s_waitcnt lgkmcnt(14)
    v_mfma_f32_16x16x32_bf16 v[224:227], v[48:51], v[40:43], v[224:227]
    s_add_u32 m0, s64, 4096
    v_add_f32 v148, v148, v0
    v_mfma_f32_16x16x32_bf16 v[228:231], v[52:55], v[40:43], v[228:231]
    s_mov_b32 s12, 2981888
    v_mfma_f32_16x16x32_bf16 v[232:235], v[56:59], v[40:43], v[232:235]
    v_lshlrev_b32_sdwa v14, 4, v111 dst_sel:DWORD dst_unused:UNUSED_PAD src0_sel:DWORD src1_sel:WORD_0
    v_mfma_f32_16x16x32_bf16 v[236:239], v[60:63], v[40:43], v[236:239]
    ds_read_b128 v[40:43], v14
    v_mfma_f32_16x16x32_bf16 v[240:243], v[48:51], v[44:47], v[240:243]
    s_waitcnt lgkmcnt(2)
    buffer_load_dwordx4 v1, s[48:51], s12 offen offset:0 lds
    v_mfma_f32_16x16x32_bf16 v[244:247], v[52:55], v[44:47], v[244:247]
    buffer_load_dwordx4 v3, s[48:51], s12 offen offset:1024 lds
    v_mfma_f32_16x16x32_bf16 v[248:251], v[56:59], v[44:47], v[248:251]
    v_lshlrev_b32_sdwa v15, 4, v111 dst_sel:DWORD dst_unused:UNUSED_PAD src0_sel:DWORD src1_sel:WORD_1
    v_mfma_f32_16x16x32_bf16 v[252:255], v[60:63], v[44:47], v[252:255]
    ds_read_b128 v[44:47], v15
    v_mov_b32 v110, v92
    v_mfma_f32_16x16x32_bf16 v[128:131], v[48:51], v[16:19], v[128:131]
    s_add_u32 m0, s64, 6144
    v_mfma_f32_16x16x32_bf16 v[132:135], v[52:55], v[16:19], v[132:135]
    s_mov_b32 s12, 3035136
    v_mfma_f32_16x16x32_bf16 v[136:139], v[56:59], v[16:19], v[136:139]
    v_lshlrev_b32_sdwa v8, 4, v90 dst_sel:DWORD dst_unused:UNUSED_PAD src0_sel:DWORD src1_sel:WORD_0
    v_permlane16_swap_b32 v92, v110
    v_mfma_f32_16x16x32_bf16 v[140:143], v[60:63], v[16:19], v[140:143]
    ds_read_b128 v[16:19], v8
    v_xor_b32 v92, v126, v92
    v_mfma_f32_16x16x32_bf16 v[144:147], v[48:51], v[20:23], v[144:147]
    buffer_load_dwordx4 v1, s[48:51], s12 offen offset:0 lds
    v_mfma_f32_16x16x32_bf16 v[148:151], v[52:55], v[20:23], v[148:151]
    buffer_load_dwordx4 v3, s[48:51], s12 offen offset:1024 lds
    v_mfma_f32_16x16x32_bf16 v[152:155], v[56:59], v[20:23], v[152:155]
    v_lshlrev_b32_sdwa v9, 4, v90 dst_sel:DWORD dst_unused:UNUSED_PAD src0_sel:DWORD src1_sel:WORD_1
    v_xor_b32 v110, v126, v110
    v_mfma_f32_16x16x32_bf16 v[156:159], v[60:63], v[20:23], v[156:159]
    ds_read_b128 v[20:23], v9
    v_mfma_f32_16x16x32_bf16 v[160:163], v[64:67], v[24:27], v[160:163]
    s_waitcnt vmcnt(4)
    ds_read_b64_tr_b16 v[48:49], v106 offset:0
    v_mfma_f32_16x16x32_bf16 v[164:167], v[68:71], v[24:27], v[164:167]
    ds_read_b64_tr_b16 v[50:51], v106 offset:512
    v_mfma_f32_16x16x32_bf16 v[168:171], v[72:75], v[24:27], v[168:171]
    v_lshlrev_b32_sdwa v10, 4, v110 dst_sel:DWORD dst_unused:UNUSED_PAD src0_sel:DWORD src1_sel:WORD_0
    v_mov_b32 v111, v93
    v_mfma_f32_16x16x32_bf16 v[172:175], v[76:79], v[24:27], v[172:175]
    ds_read_b128 v[24:27], v10
    v_mfma_f32_16x16x32_bf16 v[176:179], v[64:67], v[28:31], v[176:179]
    ds_read_b64_tr_b16 v[52:53], v107 offset:0
    v_mfma_f32_16x16x32_bf16 v[180:183], v[68:71], v[28:31], v[180:183]
    ds_read_b64_tr_b16 v[54:55], v107 offset:512
    v_and_b32 v0, 0xffff0000, v114
    v_mfma_f32_16x16x32_bf16 v[184:187], v[72:75], v[28:31], v[184:187]
    v_lshlrev_b32_sdwa v11, 4, v110 dst_sel:DWORD dst_unused:UNUSED_PAD src0_sel:DWORD src1_sel:WORD_1
    v_permlane16_swap_b32 v93, v111
    v_mfma_f32_16x16x32_bf16 v[188:191], v[76:79], v[28:31], v[188:191]
    ds_read_b128 v[28:31], v11
    v_xor_b32 v93, v126, v93
    s_waitcnt lgkmcnt(10)
    v_mfma_f32_16x16x32_bf16 v[192:195], v[64:67], v[32:35], v[192:195]
    ds_read_b64_tr_b16 v[56:57], v108 offset:0
    v_add_f32 v133, v133, v0
    v_mfma_f32_16x16x32_bf16 v[196:199], v[68:71], v[32:35], v[196:199]
    ds_read_b64_tr_b16 v[58:59], v108 offset:512
    v_add_f32 v149, v149, v0
    v_mfma_f32_16x16x32_bf16 v[200:203], v[72:75], v[32:35], v[200:203]
    v_lshlrev_b32_sdwa v12, 4, v93 dst_sel:DWORD dst_unused:UNUSED_PAD src0_sel:DWORD src1_sel:WORD_0
    v_lshlrev_b32 v0, 16, v115
    v_mfma_f32_16x16x32_bf16 v[204:207], v[76:79], v[32:35], v[204:207]
    ds_read_b128 v[32:35], v12
    v_xor_b32 v111, v126, v111
    v_mfma_f32_16x16x32_bf16 v[208:211], v[64:67], v[36:39], v[208:211]
    ds_read_b64_tr_b16 v[60:61], v109 offset:0
    v_add_f32 v134, v134, v0
    v_mfma_f32_16x16x32_bf16 v[212:215], v[68:71], v[36:39], v[212:215]
    ds_read_b64_tr_b16 v[62:63], v109 offset:512
    v_add_f32 v150, v150, v0
    v_mfma_f32_16x16x32_bf16 v[216:219], v[72:75], v[36:39], v[216:219]
    v_lshlrev_b32_sdwa v13, 4, v93 dst_sel:DWORD dst_unused:UNUSED_PAD src0_sel:DWORD src1_sel:WORD_1
    v_and_b32 v0, 0xffff0000, v115
    v_mfma_f32_16x16x32_bf16 v[220:223], v[76:79], v[36:39], v[220:223]
    ds_read_b128 v[36:39], v13
    v_add_f32 v135, v135, v0
    s_waitcnt lgkmcnt(14)
    v_mfma_f32_16x16x32_bf16 v[224:227], v[64:67], v[40:43], v[224:227]
    s_add_u32 m0, s64, 0
    v_add_f32 v151, v151, v0
    v_mfma_f32_16x16x32_bf16 v[228:231], v[68:71], v[40:43], v[228:231]
    s_mov_b32 s12, 3407872
    v_mfma_f32_16x16x32_bf16 v[232:235], v[72:75], v[40:43], v[232:235]
    v_lshlrev_b32_sdwa v14, 4, v111 dst_sel:DWORD dst_unused:UNUSED_PAD src0_sel:DWORD src1_sel:WORD_0
    v_mfma_f32_16x16x32_bf16 v[236:239], v[76:79], v[40:43], v[236:239]
    ds_read_b128 v[40:43], v14
    v_mfma_f32_16x16x32_bf16 v[240:243], v[64:67], v[44:47], v[240:243]
    s_waitcnt lgkmcnt(2)
    buffer_load_dwordx4 v1, s[48:51], s12 offen offset:0 lds
    v_mfma_f32_16x16x32_bf16 v[244:247], v[68:71], v[44:47], v[244:247]
    buffer_load_dwordx4 v3, s[48:51], s12 offen offset:1024 lds
    v_mfma_f32_16x16x32_bf16 v[248:251], v[72:75], v[44:47], v[248:251]
    v_lshlrev_b32_sdwa v15, 4, v111 dst_sel:DWORD dst_unused:UNUSED_PAD src0_sel:DWORD src1_sel:WORD_1
    v_mfma_f32_16x16x32_bf16 v[252:255], v[76:79], v[44:47], v[252:255]
    ds_read_b128 v[44:47], v15
    v_mov_b32 v110, v94
    v_mfma_f32_16x16x32_bf16 v[128:131], v[64:67], v[16:19], v[128:131]
    s_add_u32 m0, s64, 2048
    v_mfma_f32_16x16x32_bf16 v[132:135], v[68:71], v[16:19], v[132:135]
    s_mov_b32 s12, 3461120
    v_mfma_f32_16x16x32_bf16 v[136:139], v[72:75], v[16:19], v[136:139]
    v_lshlrev_b32_sdwa v8, 4, v92 dst_sel:DWORD dst_unused:UNUSED_PAD src0_sel:DWORD src1_sel:WORD_0
    v_permlane16_swap_b32 v94, v110
    v_mfma_f32_16x16x32_bf16 v[140:143], v[76:79], v[16:19], v[140:143]
    ds_read_b128 v[16:19], v8
    v_xor_b32 v94, v126, v94
    v_mfma_f32_16x16x32_bf16 v[144:147], v[64:67], v[20:23], v[144:147]
    buffer_load_dwordx4 v1, s[48:51], s12 offen offset:0 lds
    v_mfma_f32_16x16x32_bf16 v[148:151], v[68:71], v[20:23], v[148:151]
    buffer_load_dwordx4 v3, s[48:51], s12 offen offset:1024 lds
    v_mfma_f32_16x16x32_bf16 v[152:155], v[72:75], v[20:23], v[152:155]
    v_lshlrev_b32_sdwa v9, 4, v92 dst_sel:DWORD dst_unused:UNUSED_PAD src0_sel:DWORD src1_sel:WORD_1
    v_xor_b32 v110, v126, v110
    v_mfma_f32_16x16x32_bf16 v[156:159], v[76:79], v[20:23], v[156:159]
    ds_read_b128 v[20:23], v9
    v_mfma_f32_16x16x32_bf16 v[160:163], v[48:51], v[24:27], v[160:163]
    s_waitcnt vmcnt(4)
    ds_read_b64_tr_b16 v[64:65], v106 offset:4096
    v_mfma_f32_16x16x32_bf16 v[164:167], v[52:55], v[24:27], v[164:167]
    ds_read_b64_tr_b16 v[66:67], v106 offset:4608
    v_mfma_f32_16x16x32_bf16 v[168:171], v[56:59], v[24:27], v[168:171]
    v_lshlrev_b32_sdwa v10, 4, v110 dst_sel:DWORD dst_unused:UNUSED_PAD src0_sel:DWORD src1_sel:WORD_0
    v_mov_b32 v111, v95
    v_mfma_f32_16x16x32_bf16 v[172:175], v[60:63], v[24:27], v[172:175]
    ds_read_b128 v[24:27], v10
    v_mfma_f32_16x16x32_bf16 v[176:179], v[48:51], v[28:31], v[176:179]
    ds_read_b64_tr_b16 v[68:69], v107 offset:4096
    v_mfma_f32_16x16x32_bf16 v[180:183], v[52:55], v[28:31], v[180:183]
    ds_read_b64_tr_b16 v[70:71], v107 offset:4608
    v_lshlrev_b32 v0, 16, v116
    v_mfma_f32_16x16x32_bf16 v[184:187], v[56:59], v[28:31], v[184:187]
    v_lshlrev_b32_sdwa v11, 4, v110 dst_sel:DWORD dst_unused:UNUSED_PAD src0_sel:DWORD src1_sel:WORD_1
    v_permlane16_swap_b32 v95, v111
    v_mfma_f32_16x16x32_bf16 v[188:191], v[60:63], v[28:31], v[188:191]
    ds_read_b128 v[28:31], v11
    v_xor_b32 v95, v126, v95
    s_waitcnt lgkmcnt(10)
    v_mfma_f32_16x16x32_bf16 v[192:195], v[48:51], v[32:35], v[192:195]
    ds_read_b64_tr_b16 v[72:73], v108 offset:4096
    v_add_f32 v136, v136, v0
    v_mfma_f32_16x16x32_bf16 v[196:199], v[52:55], v[32:35], v[196:199]
    ds_read_b64_tr_b16 v[74:75], v108 offset:4608
    v_add_f32 v152, v152, v0
    v_mfma_f32_16x16x32_bf16 v[200:203], v[56:59], v[32:35], v[200:203]
    v_lshlrev_b32_sdwa v12, 4, v95 dst_sel:DWORD dst_unused:UNUSED_PAD src0_sel:DWORD src1_sel:WORD_0
    v_and_b32 v0, 0xffff0000, v116
    v_mfma_f32_16x16x32_bf16 v[204:207], v[60:63], v[32:35], v[204:207]
    ds_read_b128 v[32:35], v12
    v_xor_b32 v111, v126, v111
    v_mfma_f32_16x16x32_bf16 v[208:211], v[48:51], v[36:39], v[208:211]
    ds_read_b64_tr_b16 v[76:77], v109 offset:4096
    v_add_f32 v137, v137, v0
    v_mfma_f32_16x16x32_bf16 v[212:215], v[52:55], v[36:39], v[212:215]
    ds_read_b64_tr_b16 v[78:79], v109 offset:4608
    v_add_f32 v153, v153, v0
    v_mfma_f32_16x16x32_bf16 v[216:219], v[56:59], v[36:39], v[216:219]
    v_lshlrev_b32_sdwa v13, 4, v95 dst_sel:DWORD dst_unused:UNUSED_PAD src0_sel:DWORD src1_sel:WORD_1
    v_lshlrev_b32 v0, 16, v117
    v_mfma_f32_16x16x32_bf16 v[220:223], v[60:63], v[36:39], v[220:223]
    ds_read_b128 v[36:39], v13
    v_add_f32 v138, v138, v0
    s_waitcnt lgkmcnt(14)
    v_mfma_f32_16x16x32_bf16 v[224:227], v[48:51], v[40:43], v[224:227]
    s_add_u32 m0, s64, 4096
    v_add_f32 v154, v154, v0
    v_mfma_f32_16x16x32_bf16 v[228:231], v[52:55], v[40:43], v[228:231]
    s_mov_b32 s12, 3833856
    v_mfma_f32_16x16x32_bf16 v[232:235], v[56:59], v[40:43], v[232:235]
    v_lshlrev_b32_sdwa v14, 4, v111 dst_sel:DWORD dst_unused:UNUSED_PAD src0_sel:DWORD src1_sel:WORD_0
    v_mfma_f32_16x16x32_bf16 v[236:239], v[60:63], v[40:43], v[236:239]
    ds_read_b128 v[40:43], v14
    v_mfma_f32_16x16x32_bf16 v[240:243], v[48:51], v[44:47], v[240:243]
    s_waitcnt lgkmcnt(2)
    buffer_load_dwordx4 v1, s[48:51], s12 offen offset:0 lds
    v_mfma_f32_16x16x32_bf16 v[244:247], v[52:55], v[44:47], v[244:247]
    buffer_load_dwordx4 v3, s[48:51], s12 offen offset:1024 lds
    v_mfma_f32_16x16x32_bf16 v[248:251], v[56:59], v[44:47], v[248:251]
    v_lshlrev_b32_sdwa v15, 4, v111 dst_sel:DWORD dst_unused:UNUSED_PAD src0_sel:DWORD src1_sel:WORD_1
    v_mfma_f32_16x16x32_bf16 v[252:255], v[60:63], v[44:47], v[252:255]
    ds_read_b128 v[44:47], v15
    v_mov_b32 v110, v96
    v_mfma_f32_16x16x32_bf16 v[128:131], v[48:51], v[16:19], v[128:131]
    s_add_u32 m0, s64, 6144
    v_mfma_f32_16x16x32_bf16 v[132:135], v[52:55], v[16:19], v[132:135]
    s_mov_b32 s12, 3887104
    v_mfma_f32_16x16x32_bf16 v[136:139], v[56:59], v[16:19], v[136:139]
    v_lshlrev_b32_sdwa v8, 4, v94 dst_sel:DWORD dst_unused:UNUSED_PAD src0_sel:DWORD src1_sel:WORD_0
    v_permlane16_swap_b32 v96, v110
    v_mfma_f32_16x16x32_bf16 v[140:143], v[60:63], v[16:19], v[140:143]
    ds_read_b128 v[16:19], v8
    v_xor_b32 v96, v126, v96
    v_mfma_f32_16x16x32_bf16 v[144:147], v[48:51], v[20:23], v[144:147]
    buffer_load_dwordx4 v1, s[48:51], s12 offen offset:0 lds
    v_mfma_f32_16x16x32_bf16 v[148:151], v[52:55], v[20:23], v[148:151]
    buffer_load_dwordx4 v3, s[48:51], s12 offen offset:1024 lds
    v_mfma_f32_16x16x32_bf16 v[152:155], v[56:59], v[20:23], v[152:155]
    v_lshlrev_b32_sdwa v9, 4, v94 dst_sel:DWORD dst_unused:UNUSED_PAD src0_sel:DWORD src1_sel:WORD_1
    v_xor_b32 v110, v126, v110
    v_mfma_f32_16x16x32_bf16 v[156:159], v[60:63], v[20:23], v[156:159]
    ds_read_b128 v[20:23], v9
    v_mfma_f32_16x16x32_bf16 v[160:163], v[64:67], v[24:27], v[160:163]
    s_waitcnt vmcnt(4)
    ds_read_b64_tr_b16 v[48:49], v106 offset:0
    v_mfma_f32_16x16x32_bf16 v[164:167], v[68:71], v[24:27], v[164:167]
    ds_read_b64_tr_b16 v[50:51], v106 offset:512
    v_mfma_f32_16x16x32_bf16 v[168:171], v[72:75], v[24:27], v[168:171]
    v_lshlrev_b32_sdwa v10, 4, v110 dst_sel:DWORD dst_unused:UNUSED_PAD src0_sel:DWORD src1_sel:WORD_0
    v_mov_b32 v111, v97
    v_mfma_f32_16x16x32_bf16 v[172:175], v[76:79], v[24:27], v[172:175]
    ds_read_b128 v[24:27], v10
    v_mfma_f32_16x16x32_bf16 v[176:179], v[64:67], v[28:31], v[176:179]
    ds_read_b64_tr_b16 v[52:53], v107 offset:0
    v_mfma_f32_16x16x32_bf16 v[180:183], v[68:71], v[28:31], v[180:183]
    ds_read_b64_tr_b16 v[54:55], v107 offset:512
    v_and_b32 v0, 0xffff0000, v117
    v_mfma_f32_16x16x32_bf16 v[184:187], v[72:75], v[28:31], v[184:187]
    v_lshlrev_b32_sdwa v11, 4, v110 dst_sel:DWORD dst_unused:UNUSED_PAD src0_sel:DWORD src1_sel:WORD_1
    v_permlane16_swap_b32 v97, v111
    v_mfma_f32_16x16x32_bf16 v[188:191], v[76:79], v[28:31], v[188:191]
    ds_read_b128 v[28:31], v11
    v_xor_b32 v97, v126, v97
    s_waitcnt lgkmcnt(10)
    v_mfma_f32_16x16x32_bf16 v[192:195], v[64:67], v[32:35], v[192:195]
    ds_read_b64_tr_b16 v[56:57], v108 offset:0
    v_add_f32 v139, v139, v0
    v_mfma_f32_16x16x32_bf16 v[196:199], v[68:71], v[32:35], v[196:199]
    ds_read_b64_tr_b16 v[58:59], v108 offset:512
    v_add_f32 v155, v155, v0
    v_mfma_f32_16x16x32_bf16 v[200:203], v[72:75], v[32:35], v[200:203]
    v_lshlrev_b32_sdwa v12, 4, v97 dst_sel:DWORD dst_unused:UNUSED_PAD src0_sel:DWORD src1_sel:WORD_0
    v_lshlrev_b32 v0, 16, v118
    v_mfma_f32_16x16x32_bf16 v[204:207], v[76:79], v[32:35], v[204:207]
    ds_read_b128 v[32:35], v12
    v_xor_b32 v111, v126, v111
    v_mfma_f32_16x16x32_bf16 v[208:211], v[64:67], v[36:39], v[208:211]
    ds_read_b64_tr_b16 v[60:61], v109 offset:0
    v_add_f32 v140, v140, v0
    v_mfma_f32_16x16x32_bf16 v[212:215], v[68:71], v[36:39], v[212:215]
    ds_read_b64_tr_b16 v[62:63], v109 offset:512
    v_add_f32 v156, v156, v0
    v_mfma_f32_16x16x32_bf16 v[216:219], v[72:75], v[36:39], v[216:219]
    v_lshlrev_b32_sdwa v13, 4, v97 dst_sel:DWORD dst_unused:UNUSED_PAD src0_sel:DWORD src1_sel:WORD_1
    v_and_b32 v0, 0xffff0000, v118
    v_mfma_f32_16x16x32_bf16 v[220:223], v[76:79], v[36:39], v[220:223]
    ds_read_b128 v[36:39], v13
    v_add_f32 v141, v141, v0
    s_waitcnt lgkmcnt(14)
    v_mfma_f32_16x16x32_bf16 v[224:227], v[64:67], v[40:43], v[224:227]
    s_add_u32 m0, s64, 0
    v_add_f32 v157, v157, v0
    v_mfma_f32_16x16x32_bf16 v[228:231], v[68:71], v[40:43], v[228:231]
    s_mov_b32 s12, 4259840
    v_mfma_f32_16x16x32_bf16 v[232:235], v[72:75], v[40:43], v[232:235]
    v_lshlrev_b32_sdwa v14, 4, v111 dst_sel:DWORD dst_unused:UNUSED_PAD src0_sel:DWORD src1_sel:WORD_0
    v_mfma_f32_16x16x32_bf16 v[236:239], v[76:79], v[40:43], v[236:239]
    ds_read_b128 v[40:43], v14
    v_mfma_f32_16x16x32_bf16 v[240:243], v[64:67], v[44:47], v[240:243]
    s_waitcnt lgkmcnt(2)
    buffer_load_dwordx4 v1, s[48:51], s12 offen offset:0 lds
    v_mfma_f32_16x16x32_bf16 v[244:247], v[68:71], v[44:47], v[244:247]
    buffer_load_dwordx4 v3, s[48:51], s12 offen offset:1024 lds
    v_mfma_f32_16x16x32_bf16 v[248:251], v[72:75], v[44:47], v[248:251]
    v_lshlrev_b32_sdwa v15, 4, v111 dst_sel:DWORD dst_unused:UNUSED_PAD src0_sel:DWORD src1_sel:WORD_1
    v_mfma_f32_16x16x32_bf16 v[252:255], v[76:79], v[44:47], v[252:255]
    ds_read_b128 v[44:47], v15
    v_mov_b32 v110, v98
    v_mfma_f32_16x16x32_bf16 v[128:131], v[64:67], v[16:19], v[128:131]
    s_add_u32 m0, s64, 2048
    v_mfma_f32_16x16x32_bf16 v[132:135], v[68:71], v[16:19], v[132:135]
    s_mov_b32 s12, 4313088
    v_mfma_f32_16x16x32_bf16 v[136:139], v[72:75], v[16:19], v[136:139]
    v_lshlrev_b32_sdwa v8, 4, v96 dst_sel:DWORD dst_unused:UNUSED_PAD src0_sel:DWORD src1_sel:WORD_0
    v_permlane16_swap_b32 v98, v110
    v_mfma_f32_16x16x32_bf16 v[140:143], v[76:79], v[16:19], v[140:143]
    ds_read_b128 v[16:19], v8
    v_xor_b32 v98, v126, v98
    v_mfma_f32_16x16x32_bf16 v[144:147], v[64:67], v[20:23], v[144:147]
    buffer_load_dwordx4 v1, s[48:51], s12 offen offset:0 lds
    v_mfma_f32_16x16x32_bf16 v[148:151], v[68:71], v[20:23], v[148:151]
    buffer_load_dwordx4 v3, s[48:51], s12 offen offset:1024 lds
    v_mfma_f32_16x16x32_bf16 v[152:155], v[72:75], v[20:23], v[152:155]
    v_lshlrev_b32_sdwa v9, 4, v96 dst_sel:DWORD dst_unused:UNUSED_PAD src0_sel:DWORD src1_sel:WORD_1
    v_xor_b32 v110, v126, v110
    v_mfma_f32_16x16x32_bf16 v[156:159], v[76:79], v[20:23], v[156:159]
    ds_read_b128 v[20:23], v9
    v_mfma_f32_16x16x32_bf16 v[160:163], v[48:51], v[24:27], v[160:163]
    s_waitcnt vmcnt(4)
    ds_read_b64_tr_b16 v[64:65], v106 offset:4096
    v_mfma_f32_16x16x32_bf16 v[164:167], v[52:55], v[24:27], v[164:167]
    ds_read_b64_tr_b16 v[66:67], v106 offset:4608
    v_mfma_f32_16x16x32_bf16 v[168:171], v[56:59], v[24:27], v[168:171]
    v_lshlrev_b32_sdwa v10, 4, v110 dst_sel:DWORD dst_unused:UNUSED_PAD src0_sel:DWORD src1_sel:WORD_0
    v_mov_b32 v111, v99
    v_mfma_f32_16x16x32_bf16 v[172:175], v[60:63], v[24:27], v[172:175]
    ds_read_b128 v[24:27], v10
    v_mfma_f32_16x16x32_bf16 v[176:179], v[48:51], v[28:31], v[176:179]
    ds_read_b64_tr_b16 v[68:69], v107 offset:4096
    v_mfma_f32_16x16x32_bf16 v[180:183], v[52:55], v[28:31], v[180:183]
    ds_read_b64_tr_b16 v[70:71], v107 offset:4608
    v_lshlrev_b32 v0, 16, v119
    v_mfma_f32_16x16x32_bf16 v[184:187], v[56:59], v[28:31], v[184:187]
    v_lshlrev_b32_sdwa v11, 4, v110 dst_sel:DWORD dst_unused:UNUSED_PAD src0_sel:DWORD src1_sel:WORD_1
    v_permlane16_swap_b32 v99, v111
    v_mfma_f32_16x16x32_bf16 v[188:191], v[60:63], v[28:31], v[188:191]
    ds_read_b128 v[28:31], v11
    v_xor_b32 v99, v126, v99
    s_waitcnt lgkmcnt(10)
    v_mfma_f32_16x16x32_bf16 v[192:195], v[48:51], v[32:35], v[192:195]
    ds_read_b64_tr_b16 v[72:73], v108 offset:4096
    v_add_f32 v142, v142, v0
    v_mfma_f32_16x16x32_bf16 v[196:199], v[52:55], v[32:35], v[196:199]
    ds_read_b64_tr_b16 v[74:75], v108 offset:4608
    v_add_f32 v158, v158, v0
    v_mfma_f32_16x16x32_bf16 v[200:203], v[56:59], v[32:35], v[200:203]
    v_lshlrev_b32_sdwa v12, 4, v99 dst_sel:DWORD dst_unused:UNUSED_PAD src0_sel:DWORD src1_sel:WORD_0
    v_and_b32 v0, 0xffff0000, v119
    v_mfma_f32_16x16x32_bf16 v[204:207], v[60:63], v[32:35], v[204:207]
    ds_read_b128 v[32:35], v12
    v_xor_b32 v111, v126, v111
    v_mfma_f32_16x16x32_bf16 v[208:211], v[48:51], v[36:39], v[208:211]
    ds_read_b64_tr_b16 v[76:77], v109 offset:4096
    v_add_f32 v143, v143, v0
    v_mfma_f32_16x16x32_bf16 v[212:215], v[52:55], v[36:39], v[212:215]
    ds_read_b64_tr_b16 v[78:79], v109 offset:4608
    v_add_f32 v159, v159, v0
    v_mfma_f32_16x16x32_bf16 v[216:219], v[56:59], v[36:39], v[216:219]
    v_lshlrev_b32_sdwa v13, 4, v99 dst_sel:DWORD dst_unused:UNUSED_PAD src0_sel:DWORD src1_sel:WORD_1
    v_mfma_f32_16x16x32_bf16 v[220:223], v[60:63], v[36:39], v[220:223]
    ds_read_b128 v[36:39], v13
    s_waitcnt lgkmcnt(14)
    v_mfma_f32_16x16x32_bf16 v[224:227], v[48:51], v[40:43], v[224:227]
    s_add_u32 m0, s64, 4096
    v_mfma_f32_16x16x32_bf16 v[228:231], v[52:55], v[40:43], v[228:231]
    s_mov_b32 s12, 4685824
    v_mfma_f32_16x16x32_bf16 v[232:235], v[56:59], v[40:43], v[232:235]
    v_lshlrev_b32_sdwa v14, 4, v111 dst_sel:DWORD dst_unused:UNUSED_PAD src0_sel:DWORD src1_sel:WORD_0
    v_mfma_f32_16x16x32_bf16 v[236:239], v[60:63], v[40:43], v[236:239]
    ds_read_b128 v[40:43], v14
    v_mfma_f32_16x16x32_bf16 v[240:243], v[48:51], v[44:47], v[240:243]
    s_waitcnt lgkmcnt(2)
    buffer_load_dwordx4 v1, s[48:51], s12 offen offset:0 lds
    v_mfma_f32_16x16x32_bf16 v[244:247], v[52:55], v[44:47], v[244:247]
    buffer_load_dwordx4 v3, s[48:51], s12 offen offset:1024 lds
    v_mfma_f32_16x16x32_bf16 v[248:251], v[56:59], v[44:47], v[248:251]
    v_lshlrev_b32_sdwa v15, 4, v111 dst_sel:DWORD dst_unused:UNUSED_PAD src0_sel:DWORD src1_sel:WORD_1
    v_mfma_f32_16x16x32_bf16 v[252:255], v[60:63], v[44:47], v[252:255]
    ds_read_b128 v[44:47], v15
    v_mov_b32 v110, v100
    v_mfma_f32_16x16x32_bf16 v[128:131], v[48:51], v[16:19], v[128:131]
    s_add_u32 m0, s64, 6144
    v_mfma_f32_16x16x32_bf16 v[132:135], v[52:55], v[16:19], v[132:135]
    s_mov_b32 s12, 4739072
    v_mfma_f32_16x16x32_bf16 v[136:139], v[56:59], v[16:19], v[136:139]
    v_lshlrev_b32_sdwa v8, 4, v98 dst_sel:DWORD dst_unused:UNUSED_PAD src0_sel:DWORD src1_sel:WORD_0
    v_permlane16_swap_b32 v100, v110
    v_mfma_f32_16x16x32_bf16 v[140:143], v[60:63], v[16:19], v[140:143]
    ds_read_b128 v[16:19], v8
    v_xor_b32 v100, v126, v100
    v_mfma_f32_16x16x32_bf16 v[144:147], v[48:51], v[20:23], v[144:147]
    buffer_load_dwordx4 v1, s[48:51], s12 offen offset:0 lds
    v_mfma_f32_16x16x32_bf16 v[148:151], v[52:55], v[20:23], v[148:151]
    buffer_load_dwordx4 v3, s[48:51], s12 offen offset:1024 lds
    v_mfma_f32_16x16x32_bf16 v[152:155], v[56:59], v[20:23], v[152:155]
    v_lshlrev_b32_sdwa v9, 4, v98 dst_sel:DWORD dst_unused:UNUSED_PAD src0_sel:DWORD src1_sel:WORD_1
    v_xor_b32 v110, v126, v110
    v_mfma_f32_16x16x32_bf16 v[156:159], v[60:63], v[20:23], v[156:159]
    ds_read_b128 v[20:23], v9
    v_mfma_f32_16x16x32_bf16 v[160:163], v[64:67], v[24:27], v[160:163]
    s_waitcnt vmcnt(4)
    ds_read_b64_tr_b16 v[48:49], v106 offset:0
    v_mfma_f32_16x16x32_bf16 v[164:167], v[68:71], v[24:27], v[164:167]
    ds_read_b64_tr_b16 v[50:51], v106 offset:512
    v_mfma_f32_16x16x32_bf16 v[168:171], v[72:75], v[24:27], v[168:171]
    v_lshlrev_b32_sdwa v10, 4, v110 dst_sel:DWORD dst_unused:UNUSED_PAD src0_sel:DWORD src1_sel:WORD_0
    v_mov_b32 v111, v101
    v_mfma_f32_16x16x32_bf16 v[172:175], v[76:79], v[24:27], v[172:175]
    ds_read_b128 v[24:27], v10
    v_mfma_f32_16x16x32_bf16 v[176:179], v[64:67], v[28:31], v[176:179]
    ds_read_b64_tr_b16 v[52:53], v107 offset:0
    buffer_load_dwordx2 v[112:113], v6, s[60:63], 0 offen offset:0
    v_mfma_f32_16x16x32_bf16 v[180:183], v[68:71], v[28:31], v[180:183]
    ds_read_b64_tr_b16 v[54:55], v107 offset:512
    buffer_load_dwordx2 v[114:115], v6, s[60:63], 0 offen offset:32
    v_mfma_f32_16x16x32_bf16 v[184:187], v[72:75], v[28:31], v[184:187]
    v_lshlrev_b32_sdwa v11, 4, v110 dst_sel:DWORD dst_unused:UNUSED_PAD src0_sel:DWORD src1_sel:WORD_1
    v_permlane16_swap_b32 v101, v111
    v_mfma_f32_16x16x32_bf16 v[188:191], v[76:79], v[28:31], v[188:191]
    ds_read_b128 v[28:31], v11
    v_xor_b32 v101, v126, v101
    s_waitcnt lgkmcnt(10)
    v_mfma_f32_16x16x32_bf16 v[192:195], v[64:67], v[32:35], v[192:195]
    ds_read_b64_tr_b16 v[56:57], v108 offset:0
    buffer_load_dwordx2 v[116:117], v6, s[60:63], 0 offen offset:64
    v_mfma_f32_16x16x32_bf16 v[196:199], v[68:71], v[32:35], v[196:199]
    ds_read_b64_tr_b16 v[58:59], v108 offset:512
    buffer_load_dwordx2 v[118:119], v6, s[60:63], 0 offen offset:96
    v_mfma_f32_16x16x32_bf16 v[200:203], v[72:75], v[32:35], v[200:203]
    v_lshlrev_b32_sdwa v12, 4, v101 dst_sel:DWORD dst_unused:UNUSED_PAD src0_sel:DWORD src1_sel:WORD_0
    s_mov_b32 s68, 327680
    v_mfma_f32_16x16x32_bf16 v[204:207], v[76:79], v[32:35], v[204:207]
    ds_read_b128 v[32:35], v12
    v_xor_b32 v111, v126, v111
    v_mfma_f32_16x16x32_bf16 v[208:211], v[64:67], v[36:39], v[208:211]
    ds_read_b64_tr_b16 v[60:61], v109 offset:0
    buffer_load_dwordx2 v[120:121], v122, s[52:55], s68 offen
    v_mfma_f32_16x16x32_bf16 v[212:215], v[68:71], v[36:39], v[212:215]
    ds_read_b64_tr_b16 v[62:63], v109 offset:512
    v_mov_b32 v86, 1
    v_mfma_f32_16x16x32_bf16 v[216:219], v[72:75], v[36:39], v[216:219]
    v_lshlrev_b32_sdwa v13, 4, v101 dst_sel:DWORD dst_unused:UNUSED_PAD src0_sel:DWORD src1_sel:WORD_1
    v_mov_b32 v87, 3222493025
    v_mfma_f32_16x16x32_bf16 v[220:223], v[76:79], v[36:39], v[220:223]
    ds_read_b128 v[36:39], v13
    v_mov_b32 v88, 0
    s_waitcnt lgkmcnt(14)
    v_mfma_f32_16x16x32_bf16 v[224:227], v[64:67], v[40:43], v[224:227]
    s_add_u32 m0, s64, 0
    v_mov_b32 v89, 0
    v_mfma_f32_16x16x32_bf16 v[228:231], v[68:71], v[40:43], v[228:231]
    s_mov_b32 s12, 5111808
    v_mfma_f32_16x16x32_bf16 v[232:235], v[72:75], v[40:43], v[232:235]
    v_lshlrev_b32_sdwa v14, 4, v111 dst_sel:DWORD dst_unused:UNUSED_PAD src0_sel:DWORD src1_sel:WORD_0
    v_mfma_f32_16x16x32_bf16 v[236:239], v[76:79], v[40:43], v[236:239]
    ds_read_b128 v[40:43], v14
    v_mfma_f32_16x16x32_bf16 v[240:243], v[64:67], v[44:47], v[240:243]
    s_waitcnt lgkmcnt(2)
    buffer_load_dwordx4 v1, s[48:51], s12 offen offset:0 lds
    v_mfma_f32_16x16x32_bf16 v[244:247], v[68:71], v[44:47], v[244:247]
    buffer_load_dwordx4 v3, s[48:51], s12 offen offset:1024 lds
    v_mfma_f32_16x16x32_bf16 v[248:251], v[72:75], v[44:47], v[248:251]
    v_lshlrev_b32_sdwa v15, 4, v111 dst_sel:DWORD dst_unused:UNUSED_PAD src0_sel:DWORD src1_sel:WORD_1
    v_mfma_f32_16x16x32_bf16 v[252:255], v[76:79], v[44:47], v[252:255]
    ds_read_b128 v[44:47], v15
    v_mov_b32 v110, v102
    v_mfma_f32_16x16x32_bf16 v[128:131], v[64:67], v[16:19], v[128:131]
    s_add_u32 m0, s64, 2048
    v_mfma_f32_16x16x32_bf16 v[132:135], v[68:71], v[16:19], v[132:135]
    s_mov_b32 s12, 5165056
    v_mfma_f32_16x16x32_bf16 v[136:139], v[72:75], v[16:19], v[136:139]
    v_lshlrev_b32_sdwa v8, 4, v100 dst_sel:DWORD dst_unused:UNUSED_PAD src0_sel:DWORD src1_sel:WORD_0
    v_permlane16_swap_b32 v102, v110
    v_mfma_f32_16x16x32_bf16 v[140:143], v[76:79], v[16:19], v[140:143]
    ds_read_b128 v[16:19], v8
    v_xor_b32 v102, v126, v102
    v_mfma_f32_16x16x32_bf16 v[144:147], v[64:67], v[20:23], v[144:147]
    buffer_load_dwordx4 v1, s[48:51], s12 offen offset:0 lds
    v_mfma_f32_16x16x32_bf16 v[148:151], v[68:71], v[20:23], v[148:151]
    buffer_load_dwordx4 v3, s[48:51], s12 offen offset:1024 lds
    v_mfma_f32_16x16x32_bf16 v[152:155], v[72:75], v[20:23], v[152:155]
    v_lshlrev_b32_sdwa v9, 4, v100 dst_sel:DWORD dst_unused:UNUSED_PAD src0_sel:DWORD src1_sel:WORD_1
    v_xor_b32 v110, v126, v110
    v_mfma_f32_16x16x32_bf16 v[156:159], v[76:79], v[20:23], v[156:159]
    ds_read_b128 v[20:23], v9
    v_mfma_f32_16x16x32_bf16 v[160:163], v[48:51], v[24:27], v[160:163]
    s_waitcnt vmcnt(9)
    ds_read_b64_tr_b16 v[64:65], v106 offset:4096
    v_mfma_f32_16x16x32_bf16 v[164:167], v[52:55], v[24:27], v[164:167]
    ds_read_b64_tr_b16 v[66:67], v106 offset:4608
    v_mfma_f32_16x16x32_bf16 v[168:171], v[56:59], v[24:27], v[168:171]
    v_lshlrev_b32_sdwa v10, 4, v110 dst_sel:DWORD dst_unused:UNUSED_PAD src0_sel:DWORD src1_sel:WORD_0
    v_mov_b32 v111, v103
    v_mfma_f32_16x16x32_bf16 v[172:175], v[60:63], v[24:27], v[172:175]
    ds_read_b128 v[24:27], v10
    v_mfma_f32_16x16x32_bf16 v[176:179], v[48:51], v[28:31], v[176:179]
    ds_read_b64_tr_b16 v[68:69], v107 offset:4096
    v_and_b32 v0, 15, v2
    v_mfma_f32_16x16x32_bf16 v[180:183], v[52:55], v[28:31], v[180:183]
    ds_read_b64_tr_b16 v[70:71], v107 offset:4608
    v_lshlrev_b32 v90, 2, v4
    v_mfma_f32_16x16x32_bf16 v[184:187], v[56:59], v[28:31], v[184:187]
    v_lshlrev_b32_sdwa v11, 4, v110 dst_sel:DWORD dst_unused:UNUSED_PAD src0_sel:DWORD src1_sel:WORD_1
    v_permlane16_swap_b32 v103, v111
    v_mfma_f32_16x16x32_bf16 v[188:191], v[60:63], v[28:31], v[188:191]
    ds_read_b128 v[28:31], v11
    v_xor_b32 v103, v126, v103
    s_waitcnt lgkmcnt(10)
    v_mfma_f32_16x16x32_bf16 v[192:195], v[48:51], v[32:35], v[192:195]
    ds_read_b64_tr_b16 v[72:73], v108 offset:4096
    v_sub_u32 v0, v0, v90
    v_mfma_f32_16x16x32_bf16 v[196:199], v[52:55], v[32:35], v[196:199]
    ds_read_b64_tr_b16 v[74:75], v108 offset:4608
    s_movk_i32 s73, 0x3f80
    v_mfma_f32_16x16x32_bf16 v[200:203], v[56:59], v[32:35], v[200:203]
    v_lshlrev_b32_sdwa v12, 4, v103 dst_sel:DWORD dst_unused:UNUSED_PAD src0_sel:DWORD src1_sel:WORD_0
    v_lshlrev_b32 v90, 4, v0
    v_mfma_f32_16x16x32_bf16 v[204:207], v[60:63], v[32:35], v[204:207]
    ds_read_b128 v[32:35], v12
    v_xor_b32 v111, v126, v111
    v_mfma_f32_16x16x32_bf16 v[208:211], v[48:51], v[36:39], v[208:211]
    ds_read_b64_tr_b16 v[76:77], v109 offset:4096
    v_and_b32 v90, 16, v90
    v_mfma_f32_16x16x32_bf16 v[212:215], v[52:55], v[36:39], v[212:215]
    ds_read_b64_tr_b16 v[78:79], v109 offset:4608
    v_lshlrev_b32 v90, v90, s73
    v_mfma_f32_16x16x32_bf16 v[216:219], v[56:59], v[36:39], v[216:219]
    v_lshlrev_b32_sdwa v13, 4, v103 dst_sel:DWORD dst_unused:UNUSED_PAD src0_sel:DWORD src1_sel:WORD_1
    v_lshrrev_b32 v0, 1, v0
    v_mfma_f32_16x16x32_bf16 v[220:223], v[60:63], v[36:39], v[220:223]
    ds_read_b128 v[36:39], v13
    v_cmp_eq_u32 s[66:67], 0, v0
    s_waitcnt lgkmcnt(14)
    v_mfma_f32_16x16x32_bf16 v[224:227], v[48:51], v[40:43], v[224:227]
    v_cmp_eq_u32 s[68:69], 1, v0
    v_mov_b32 v80, 0
    v_mfma_f32_16x16x32_bf16 v[228:231], v[52:55], v[40:43], v[228:231]
    s_waitcnt lgkmcnt(1)
    s_mov_b64 exec, 1
    ds_add_u32 v7, v86 offset:16
    s_mov_b64 exec, -1
    v_mfma_f32_16x16x32_bf16 v[232:235], v[56:59], v[40:43], v[232:235]
    v_lshlrev_b32_sdwa v14, 4, v111 dst_sel:DWORD dst_unused:UNUSED_PAD src0_sel:DWORD src1_sel:WORD_0
    v_mov_b32 v81, 0
    v_mfma_f32_16x16x32_bf16 v[236:239], v[60:63], v[40:43], v[236:239]
    ds_read_b128 v[40:43], v14
    v_cndmask_b32 v82, 0, v90, s[66:67]
    v_mfma_f32_16x16x32_bf16 v[240:243], v[48:51], v[44:47], v[240:243]
    v_cndmask_b32 v83, 0, v90, s[68:69]
    v_mov_b32 v84, 0
    v_mfma_f32_16x16x32_bf16 v[244:247], v[52:55], v[44:47], v[244:247]
    v_mov_b32 v85, 0
    v_mfma_f32_16x16x32_bf16 v[248:251], v[56:59], v[44:47], v[248:251]
    v_lshlrev_b32_sdwa v15, 4, v111 dst_sel:DWORD dst_unused:UNUSED_PAD src0_sel:DWORD src1_sel:WORD_1
    v_mfma_f32_16x16x32_bf16 v[252:255], v[60:63], v[44:47], v[252:255]
    ds_read_b128 v[44:47], v15
    v_mov_b32 v110, v104
    v_mfma_f32_16x16x32_bf16 v[128:131], v[48:51], v[16:19], v[128:131]
    v_mfma_f32_16x16x32_bf16 v[132:135], v[52:55], v[16:19], v[132:135]
    v_mfma_f32_16x16x32_bf16 v[136:139], v[56:59], v[16:19], v[136:139]
    v_lshlrev_b32_sdwa v8, 4, v102 dst_sel:DWORD dst_unused:UNUSED_PAD src0_sel:DWORD src1_sel:WORD_0
    v_permlane16_swap_b32 v104, v110
    v_mfma_f32_16x16x32_bf16 v[140:143], v[60:63], v[16:19], v[140:143]
    ds_read_b128 v[16:19], v8
    v_xor_b32 v104, v126, v104
    v_mfma_f32_16x16x32_bf16 v[144:147], v[48:51], v[20:23], v[144:147]
    v_mfma_f32_16x16x32_bf16 v[148:151], v[52:55], v[20:23], v[148:151]
    v_mfma_f32_16x16x32_bf16 v[152:155], v[56:59], v[20:23], v[152:155]
    v_lshlrev_b32_sdwa v9, 4, v102 dst_sel:DWORD dst_unused:UNUSED_PAD src0_sel:DWORD src1_sel:WORD_1
    v_xor_b32 v110, v126, v110
    v_mfma_f32_16x16x32_bf16 v[156:159], v[60:63], v[20:23], v[156:159]
    ds_read_b128 v[20:23], v9
    v_mfma_f32_16x16x32_bf16 v[160:163], v[64:67], v[24:27], v[160:163]
    s_waitcnt vmcnt(0)
    ds_read_b64_tr_b16 v[48:49], v106 offset:0
    v_mfma_f32_16x16x32_bf16 v[164:167], v[68:71], v[24:27], v[164:167]
    ds_read_b64_tr_b16 v[50:51], v106 offset:512
    v_mfma_f32_16x16x32_bf16 v[168:171], v[72:75], v[24:27], v[168:171]
    v_lshlrev_b32_sdwa v10, 4, v110 dst_sel:DWORD dst_unused:UNUSED_PAD src0_sel:DWORD src1_sel:WORD_0
    v_mov_b32 v111, v105
    v_mfma_f32_16x16x32_bf16 v[172:175], v[76:79], v[24:27], v[172:175]
    ds_read_b128 v[24:27], v10
    v_mfma_f32_16x16x32_bf16 v[176:179], v[64:67], v[28:31], v[176:179]
    ds_read_b64_tr_b16 v[52:53], v107 offset:0
    s_waitcnt vmcnt(0)
    v_mfma_f32_16x16x32_bf16 v[180:183], v[68:71], v[28:31], v[180:183]
    ds_read_b64_tr_b16 v[54:55], v107 offset:512
    v_lshlrev_b32 v92, 16, v112
    v_mfma_f32_16x16x32_bf16 v[184:187], v[72:75], v[28:31], v[184:187]
    v_lshlrev_b32_sdwa v11, 4, v110 dst_sel:DWORD dst_unused:UNUSED_PAD src0_sel:DWORD src1_sel:WORD_1
    v_permlane16_swap_b32 v105, v111
    v_mfma_f32_16x16x32_bf16 v[188:191], v[76:79], v[28:31], v[188:191]
    ds_read_b128 v[28:31], v11
    v_xor_b32 v105, v126, v105
    s_waitcnt lgkmcnt(11)
    v_mfma_f32_16x16x32_bf16 v[192:195], v[64:67], v[32:35], v[192:195]
    ds_read_b64_tr_b16 v[56:57], v108 offset:0
    v_and_b32 v112, 0xffff0000, v112
    v_mfma_f32_16x16x32_bf16 v[196:199], v[68:71], v[32:35], v[196:199]
    ds_read_b64_tr_b16 v[58:59], v108 offset:512
    v_lshlrev_b32 v93, 16, v113
    v_mfma_f32_16x16x32_bf16 v[200:203], v[72:75], v[32:35], v[200:203]
    v_lshlrev_b32_sdwa v12, 4, v105 dst_sel:DWORD dst_unused:UNUSED_PAD src0_sel:DWORD src1_sel:WORD_0
    v_and_b32 v113, 0xffff0000, v113
    v_mfma_f32_16x16x32_bf16 v[204:207], v[76:79], v[32:35], v[204:207]
    ds_read_b128 v[32:35], v12
    v_xor_b32 v111, v126, v111
    v_mfma_f32_16x16x32_bf16 v[208:211], v[64:67], v[36:39], v[208:211]
    ds_read_b64_tr_b16 v[60:61], v109 offset:0
    v_lshlrev_b32 v94, 16, v114
    v_mfma_f32_16x16x32_bf16 v[212:215], v[68:71], v[36:39], v[212:215]
    ds_read_b64_tr_b16 v[62:63], v109 offset:512
    v_and_b32 v114, 0xffff0000, v114
    v_mfma_f32_16x16x32_bf16 v[216:219], v[72:75], v[36:39], v[216:219]
    v_lshlrev_b32_sdwa v13, 4, v105 dst_sel:DWORD dst_unused:UNUSED_PAD src0_sel:DWORD src1_sel:WORD_1
    v_lshlrev_b32 v95, 16, v115
    v_mfma_f32_16x16x32_bf16 v[220:223], v[76:79], v[36:39], v[220:223]
    ds_read_b128 v[36:39], v13
    v_and_b32 v115, 0xffff0000, v115
    s_waitcnt lgkmcnt(14)
    v_mfma_f32_16x16x32_bf16 v[224:227], v[64:67], v[40:43], v[224:227]
    v_lshlrev_b32 v96, 16, v116
    v_and_b32 v116, 0xffff0000, v116
    v_mfma_f32_16x16x32_bf16 v[228:231], v[68:71], v[40:43], v[228:231]
    v_lshlrev_b32 v97, 16, v117
    v_and_b32 v117, 0xffff0000, v117
    v_mfma_f32_16x16x32_bf16 v[232:235], v[72:75], v[40:43], v[232:235]
    v_lshlrev_b32_sdwa v14, 4, v111 dst_sel:DWORD dst_unused:UNUSED_PAD src0_sel:DWORD src1_sel:WORD_0
    v_lshlrev_b32 v98, 16, v118
    v_mfma_f32_16x16x32_bf16 v[236:239], v[76:79], v[40:43], v[236:239]
    ds_read_b128 v[40:43], v14
    v_and_b32 v118, 0xffff0000, v118
    v_mfma_f32_16x16x32_bf16 v[240:243], v[64:67], v[44:47], v[240:243]
    v_lshlrev_b32 v99, 16, v119
    v_and_b32 v119, 0xffff0000, v119
    v_mfma_f32_16x16x32_bf16 v[244:247], v[68:71], v[44:47], v[244:247]
    v_mfma_f32_16x16x32_bf16 v[248:251], v[72:75], v[44:47], v[248:251]
    v_lshlrev_b32_sdwa v15, 4, v111 dst_sel:DWORD dst_unused:UNUSED_PAD src0_sel:DWORD src1_sel:WORD_1
    v_mfma_f32_16x16x32_bf16 v[252:255], v[76:79], v[44:47], v[252:255]
    ds_read_b128 v[44:47], v15
    s_waitcnt lgkmcnt(14)
    v_mfma_f32_16x16x32_bf16 v[128:131], v[64:67], v[16:19], v[128:131]
    v_mfma_f32_16x16x32_bf16 v[132:135], v[68:71], v[16:19], v[132:135]
    v_mfma_f32_16x16x32_bf16 v[136:139], v[72:75], v[16:19], v[136:139]
    v_lshlrev_b32_sdwa v8, 4, v104 dst_sel:DWORD dst_unused:UNUSED_PAD src0_sel:DWORD src1_sel:WORD_0
    v_mfma_f32_16x16x32_bf16 v[140:143], v[76:79], v[16:19], v[140:143]
    ds_read_b128 v[16:19], v8
    v_mfma_f32_16x16x32_bf16 v[144:147], v[64:67], v[20:23], v[144:147]
    v_mfma_f32_16x16x32_bf16 v[148:151], v[68:71], v[20:23], v[148:151]
    v_mfma_f32_16x16x32_bf16 v[152:155], v[72:75], v[20:23], v[152:155]
    v_lshlrev_b32_sdwa v9, 4, v104 dst_sel:DWORD dst_unused:UNUSED_PAD src0_sel:DWORD src1_sel:WORD_1
    v_mfma_f32_16x16x32_bf16 v[156:159], v[76:79], v[20:23], v[156:159]
    ds_read_b128 v[20:23], v9
    s_waitcnt lgkmcnt(5)
    v_mfma_f32_16x16x32_bf16 v[160:163], v[48:51], v[24:27], v[160:163]
    v_mfma_f32_16x16x32_bf16 v[164:167], v[52:55], v[24:27], v[164:167]
    v_mfma_f32_16x16x32_bf16 v[168:171], v[56:59], v[24:27], v[168:171]
    s_waitcnt lgkmcnt(0)
    s_barrier
    v_mfma_f32_16x16x32_bf16 v[172:175], v[60:63], v[24:27], v[172:175]
    v_mfma_f32_16x16x32_bf16 v[176:179], v[48:51], v[28:31], v[176:179]
    v_mfma_f32_16x16x32_bf16 v[180:183], v[52:55], v[28:31], v[180:183]
    s_nop 0
    v_cvt_pk_bf16_f32 v160, v160, v161
    v_cvt_pk_bf16_f32 v161, v162, v163
    v_cvt_pk_bf16_f32 v162, v164, v165
    v_mfma_f32_16x16x32_bf16 v[184:187], v[56:59], v[28:31], v[184:187]
    v_cvt_pk_bf16_f32 v163, v166, v167
    ds_write_b128 v123, v[160:163] offset:0
    v_cvt_pk_bf16_f32 v164, v168, v169
    v_mfma_f32_16x16x32_bf16 v[188:191], v[60:63], v[28:31], v[188:191]
    v_cvt_pk_bf16_f32 v165, v170, v171
    v_cvt_pk_bf16_f32 v166, v172, v173
    v_cvt_pk_bf16_f32 v167, v174, v175
    v_mfma_f32_16x16x32_bf16 v[192:195], v[48:51], v[32:35], v[192:195]
    v_mfma_f32_16x16x32_bf16 v[196:199], v[52:55], v[32:35], v[196:199]
    ds_write_b128 v123, v[164:167] offset:1024
    v_cvt_pk_bf16_f32 v176, v176, v177
    v_cvt_pk_bf16_f32 v177, v178, v179
    v_mfma_f32_16x16x32_bf16 v[200:203], v[56:59], v[32:35], v[200:203]
    v_cvt_pk_bf16_f32 v178, v180, v181
    v_cvt_pk_bf16_f32 v179, v182, v183
    ds_write_b128 v123, v[176:179] offset:2048
    v_mfma_f32_16x16x32_bf16 v[204:207], v[60:63], v[32:35], v[204:207]
    v_cvt_pk_bf16_f32 v180, v184, v185
    v_cvt_pk_bf16_f32 v181, v186, v187
    v_cvt_pk_bf16_f32 v182, v188, v189
    v_mfma_f32_16x16x32_bf16 v[208:211], v[48:51], v[36:39], v[208:211]
    v_mfma_f32_16x16x32_bf16 v[212:215], v[52:55], v[36:39], v[212:215]
    v_cvt_pk_bf16_f32 v183, v190, v191
    ds_write_b128 v123, v[180:183] offset:3072
    v_cvt_pk_bf16_f32 v192, v192, v193
    v_mfma_f32_16x16x32_bf16 v[216:219], v[56:59], v[36:39], v[216:219]
    v_cvt_pk_bf16_f32 v193, v194, v195
    v_cvt_pk_bf16_f32 v194, v196, v197
    v_cvt_pk_bf16_f32 v195, v198, v199
    v_mfma_f32_16x16x32_bf16 v[220:223], v[60:63], v[36:39], v[220:223]
    ds_write_b128 v124, v[192:195] offset:16384
    v_cvt_pk_bf16_f32 v196, v200, v201
    v_cvt_pk_bf16_f32 v197, v202, v203
    v_mfma_f32_16x16x32_bf16 v[224:227], v[48:51], v[40:43], v[224:227]
    v_mfma_f32_16x16x32_bf16 v[228:231], v[52:55], v[40:43], v[228:231]
    v_cvt_pk_bf16_f32 v198, v204, v205
    v_cvt_pk_bf16_f32 v199, v206, v207
    ds_write_b128 v124, v[196:199] offset:17408
    v_mfma_f32_16x16x32_bf16 v[232:235], v[56:59], v[40:43], v[232:235]
    v_cvt_pk_bf16_f32 v208, v208, v209
    v_cvt_pk_bf16_f32 v209, v210, v211
    v_cvt_pk_bf16_f32 v210, v212, v213
    v_mfma_f32_16x16x32_bf16 v[236:239], v[60:63], v[40:43], v[236:239]
    v_cvt_pk_bf16_f32 v211, v214, v215
    ds_write_b128 v124, v[208:211] offset:18432
    v_cvt_pk_bf16_f32 v212, v216, v217
    v_mfma_f32_16x16x32_bf16 v[240:243], v[48:51], v[44:47], v[240:243]
    v_mfma_f32_16x16x32_bf16 v[244:247], v[52:55], v[44:47], v[244:247]
    v_cvt_pk_bf16_f32 v213, v218, v219
    v_cvt_pk_bf16_f32 v214, v220, v221
    v_cvt_pk_bf16_f32 v215, v222, v223
    v_mfma_f32_16x16x32_bf16 v[248:251], v[56:59], v[44:47], v[248:251]
    ds_write_b128 v124, v[212:215] offset:19456
    v_cvt_pk_bf16_f32 v224, v224, v225
    v_cvt_pk_bf16_f32 v225, v226, v227
    v_mfma_f32_16x16x32_bf16 v[252:255], v[60:63], v[44:47], v[252:255]
    v_cvt_pk_bf16_f32 v226, v228, v229
    v_cvt_pk_bf16_f32 v227, v230, v231
    ds_write_b128 v125, v[224:227] offset:32768
    v_mfma_f32_16x16x32_bf16 v[128:131], v[48:51], v[16:19], v[128:131]
    v_mfma_f32_16x16x32_bf16 v[132:135], v[52:55], v[16:19], v[132:135]
    v_cvt_pk_bf16_f32 v228, v232, v233
    v_cvt_pk_bf16_f32 v229, v234, v235
    v_cvt_pk_bf16_f32 v230, v236, v237
    v_mfma_f32_16x16x32_bf16 v[136:139], v[56:59], v[16:19], v[136:139]
    v_cvt_pk_bf16_f32 v231, v238, v239
    ds_write_b128 v125, v[228:231] offset:33792
    v_cvt_pk_bf16_f32 v240, v240, v241
    v_mfma_f32_16x16x32_bf16 v[140:143], v[60:63], v[16:19], v[140:143]
    v_cvt_pk_bf16_f32 v241, v242, v243
    v_cvt_pk_bf16_f32 v242, v244, v245
    v_cvt_pk_bf16_f32 v243, v246, v247
    v_mfma_f32_16x16x32_bf16 v[144:147], v[48:51], v[20:23], v[144:147]
    ds_write_b128 v125, v[240:243] offset:34816
    v_cvt_pk_bf16_f32 v244, v248, v249
    v_cvt_pk_bf16_f32 v245, v250, v251
    v_mfma_f32_16x16x32_bf16 v[148:151], v[52:55], v[20:23], v[148:151]
    v_cvt_pk_bf16_f32 v246, v252, v253
    v_cvt_pk_bf16_f32 v247, v254, v255
    ds_write_b128 v125, v[244:247] offset:35840
    v_mfma_f32_16x16x32_bf16 v[152:155], v[56:59], v[20:23], v[152:155]
    s_mov_b64 exec, 1
    ds_add_u32 v7, v86 offset:4
    s_mov_b64 exec, -1
    s_mov_b32 s68, 3184710632
    v_mfma_f32_16x16x32_bf16 v[156:159], v[60:63], v[20:23], v[156:159]
    s_mov_b32 s70, 16000000
L_red:
    ds_read_b32 v0, v7 offset:4
    s_waitcnt lgkmcnt(0)
    v_readfirstlane_b32 s71, v0
    s_cmp_ge_u32 s71, 4
    s_cbranch_scc1 L_red_x
    s_sub_u32 s70, s70, 1
    s_cbranch_scc0 L_red
L_red_x:
    ds_read_b128 v[160:163], v5 offset:0
    ds_read_b128 v[164:167], v5 offset:1024
    ds_read_b128 v[192:195], v5 offset:16384
    ds_read_b128 v[196:199], v5 offset:17408
    ds_read_b128 v[224:227], v5 offset:32768
    ds_read_b128 v[228:231], v5 offset:33792
    ds_read_b128 v[176:179], v5 offset:2048
    ds_read_b128 v[180:183], v5 offset:3072
    ds_read_b128 v[208:211], v5 offset:18432
    ds_read_b128 v[212:215], v5 offset:19456
    ds_read_b128 v[240:243], v5 offset:34816
    ds_read_b128 v[244:247], v5 offset:35840
    s_waitcnt lgkmcnt(11)
    v_mfma_f32_16x16x32_bf16 v[128:131], v[82:85], v[160:163], v[128:131]
    v_mfma_f32_16x16x32_bf16 v[132:135], v[80:83], v[160:163], v[132:135]
    s_waitcnt lgkmcnt(10)
    v_mfma_f32_16x16x32_bf16 v[136:139], v[82:85], v[164:167], v[136:139]
    v_mfma_f32_16x16x32_bf16 v[140:143], v[80:83], v[164:167], v[140:143]
    s_waitcnt lgkmcnt(9)
    v_mfma_f32_16x16x32_bf16 v[128:131], v[82:85], v[192:195], v[128:131]
    v_mfma_f32_16x16x32_bf16 v[132:135], v[80:83], v[192:195], v[132:135]
    s_waitcnt lgkmcnt(8)
    v_mfma_f32_16x16x32_bf16 v[136:139], v[82:85], v[196:199], v[136:139]
    v_mfma_f32_16x16x32_bf16 v[140:143], v[80:83], v[196:199], v[140:143]
    s_waitcnt lgkmcnt(7)
    v_mfma_f32_16x16x32_bf16 v[128:131], v[82:85], v[224:227], v[128:131]
    v_mfma_f32_16x16x32_bf16 v[132:135], v[80:83], v[224:227], v[132:135]
    s_waitcnt lgkmcnt(6)
    v_mfma_f32_16x16x32_bf16 v[136:139], v[82:85], v[228:231], v[136:139]
    v_mfma_f32_16x16x32_bf16 v[140:143], v[80:83], v[228:231], v[140:143]
    s_waitcnt lgkmcnt(5)
    v_mfma_f32_16x16x32_bf16 v[144:147], v[82:85], v[176:179], v[144:147]
    s_nop 1
    v_mul_f32 v48, v128, v128
    v_mul_f32 v49, v129, v129
    v_mul_f32 v50, v130, v130
    v_mul_f32 v51, v131, v131
    v_mfma_f32_16x16x32_bf16 v[148:151], v[80:83], v[176:179], v[148:151]
    v_fma_f32 v48, v48, s68, v87
    v_fma_f32 v49, v49, s68, v87
    v_fma_f32 v50, v50, s68, v87
    v_fma_f32 v51, v51, s68, v87
    s_waitcnt lgkmcnt(4)
    v_mfma_f32_16x16x32_bf16 v[152:155], v[82:85], v[180:183], v[152:155]
    v_mul_f32 v48, v48, v128
    v_mul_f32 v49, v49, v129
    v_mul_f32 v50, v50, v130
    v_mul_f32 v51, v51, v131
    v_mfma_f32_16x16x32_bf16 v[156:159], v[80:83], v[180:183], v[156:159]
    v_exp_f32 v48, v48
    v_exp_f32 v49, v49
    v_exp_f32 v50, v50
    v_exp_f32 v51, v51
    s_waitcnt lgkmcnt(3)
    v_mfma_f32_16x16x32_bf16 v[144:147], v[82:85], v[208:211], v[144:147]
    v_mul_f32 v128, v128, v92
    v_mul_f32 v129, v129, v112
    v_mul_f32 v130, v130, v93
    v_mul_f32 v131, v131, v113
    v_add_f32 v48, 1.0, v48
    v_add_f32 v49, 1.0, v49
    v_add_f32 v50, 1.0, v50
    v_add_f32 v51, 1.0, v51
    v_rcp_f32 v48, v48
    v_rcp_f32 v49, v49
    v_rcp_f32 v50, v50
    v_rcp_f32 v51, v51
    v_mfma_f32_16x16x32_bf16 v[148:151], v[80:83], v[208:211], v[148:151]
    v_fmac_f32 v88, v128, v48
    v_fmac_f32 v88, v129, v49
    v_fmac_f32 v88, v130, v50
    v_fmac_f32 v88, v131, v51
    v_mul_f32 v48, v132, v132
    v_mul_f32 v49, v133, v133
    v_mul_f32 v50, v134, v134
    v_mul_f32 v51, v135, v135
    s_waitcnt lgkmcnt(2)
    v_mfma_f32_16x16x32_bf16 v[152:155], v[82:85], v[212:215], v[152:155]
    v_fma_f32 v48, v48, s68, v87
    v_fma_f32 v49, v49, s68, v87
    v_fma_f32 v50, v50, s68, v87
    v_fma_f32 v51, v51, s68, v87
    v_mfma_f32_16x16x32_bf16 v[156:159], v[80:83], v[212:215], v[156:159]
    v_mul_f32 v48, v48, v132
    v_mul_f32 v49, v49, v133
    v_mul_f32 v50, v50, v134
    v_mul_f32 v51, v51, v135
    s_waitcnt lgkmcnt(1)
    v_mfma_f32_16x16x32_bf16 v[144:147], v[82:85], v[240:243], v[144:147]
    v_exp_f32 v48, v48
    v_exp_f32 v49, v49
    v_exp_f32 v50, v50
    v_exp_f32 v51, v51
    v_mfma_f32_16x16x32_bf16 v[148:151], v[80:83], v[240:243], v[148:151]
    v_mul_f32 v132, v132, v94
    v_mul_f32 v133, v133, v114
    v_mul_f32 v134, v134, v95
    v_mul_f32 v135, v135, v115
    v_add_f32 v48, 1.0, v48
    v_add_f32 v49, 1.0, v49
    v_add_f32 v50, 1.0, v50
    v_add_f32 v51, 1.0, v51
    v_rcp_f32 v48, v48
    v_rcp_f32 v49, v49
    v_rcp_f32 v50, v50
    v_rcp_f32 v51, v51
    s_waitcnt lgkmcnt(0)
    v_mfma_f32_16x16x32_bf16 v[152:155], v[82:85], v[244:247], v[152:155]
    v_fmac_f32 v88, v132, v48
    v_fmac_f32 v88, v133, v49
    v_fmac_f32 v88, v134, v50
    v_fmac_f32 v88, v135, v51
    v_mul_f32 v48, v136, v136
    v_mul_f32 v49, v137, v137
    v_mul_f32 v50, v138, v138
    v_mul_f32 v51, v139, v139
    v_mfma_f32_16x16x32_bf16 v[156:159], v[80:83], v[244:247], v[156:159]
    v_fma_f32 v48, v48, s68, v87
    v_fma_f32 v49, v49, s68, v87
    v_fma_f32 v50, v50, s68, v87
    v_fma_f32 v51, v51, s68, v87
    v_mul_f32 v48, v48, v136
    v_mul_f32 v49, v49, v137
    v_mul_f32 v50, v50, v138
    v_mul_f32 v51, v51, v139
    v_exp_f32 v48, v48
    v_exp_f32 v49, v49
    v_exp_f32 v50, v50
    v_exp_f32 v51, v51
    v_mul_f32 v136, v136, v96
    v_mul_f32 v137, v137, v116
    v_mul_f32 v138, v138, v97
    v_mul_f32 v139, v139, v117
    v_add_f32 v48, 1.0, v48
    v_add_f32 v49, 1.0, v49
    v_add_f32 v50, 1.0, v50
    v_add_f32 v51, 1.0, v51
    v_rcp_f32 v48, v48
    v_rcp_f32 v49, v49
    v_rcp_f32 v50, v50
    v_rcp_f32 v51, v51
    s_nop 0
    v_fmac_f32 v88, v136, v48
    v_fmac_f32 v88, v137, v49
    v_fmac_f32 v88, v138, v50
    v_fmac_f32 v88, v139, v51
    v_mul_f32 v48, v140, v140
    v_mul_f32 v49, v141, v141
    v_mul_f32 v50, v142, v142
    v_mul_f32 v51, v143, v143
    v_fma_f32 v48, v48, s68, v87
    v_fma_f32 v49, v49, s68, v87
    v_fma_f32 v50, v50, s68, v87
    v_fma_f32 v51, v51, s68, v87
    v_mul_f32 v48, v48, v140
    v_mul_f32 v49, v49, v141
    v_mul_f32 v50, v50, v142
    v_mul_f32 v51, v51, v143
    v_exp_f32 v48, v48
    v_exp_f32 v49, v49
    v_exp_f32 v50, v50
    v_exp_f32 v51, v51
    v_mul_f32 v140, v140, v98
    v_mul_f32 v141, v141, v118
    v_mul_f32 v142, v142, v99
    v_mul_f32 v143, v143, v119
    v_add_f32 v48, 1.0, v48
    v_add_f32 v49, 1.0, v49
    v_add_f32 v50, 1.0, v50
    v_add_f32 v51, 1.0, v51
    v_rcp_f32 v48, v48
    v_rcp_f32 v49, v49
    v_rcp_f32 v50, v50
    v_rcp_f32 v51, v51
    s_nop 0
    v_fmac_f32 v88, v140, v48
    v_fmac_f32 v88, v141, v49
    v_fmac_f32 v88, v142, v50
    v_fmac_f32 v88, v143, v51
    v_mul_f32 v48, v144, v144
    v_mul_f32 v49, v145, v145
    v_mul_f32 v50, v146, v146
    v_mul_f32 v51, v147, v147
    v_fma_f32 v48, v48, s68, v87
    v_fma_f32 v49, v49, s68, v87
    v_fma_f32 v50, v50, s68, v87
    v_fma_f32 v51, v51, s68, v87
    v_mul_f32 v48, v48, v144
    v_mul_f32 v49, v49, v145
    v_mul_f32 v50, v50, v146
    v_mul_f32 v51, v51, v147
    v_exp_f32 v48, v48
    v_exp_f32 v49, v49
    v_exp_f32 v50, v50
    v_exp_f32 v51, v51
    v_mul_f32 v144, v144, v92
    v_mul_f32 v145, v145, v112
    v_mul_f32 v146, v146, v93
    v_mul_f32 v147, v147, v113
    v_add_f32 v48, 1.0, v48
    v_add_f32 v49, 1.0, v49
    v_add_f32 v50, 1.0, v50
    v_add_f32 v51, 1.0, v51
    v_rcp_f32 v48, v48
    v_rcp_f32 v49, v49
    v_rcp_f32 v50, v50
    v_rcp_f32 v51, v51
    s_nop 0
    v_fmac_f32 v89, v144, v48
    v_fmac_f32 v89, v145, v49
    v_fmac_f32 v89, v146, v50
    v_fmac_f32 v89, v147, v51
    v_mul_f32 v48, v148, v148
    v_mul_f32 v49, v149, v149
    v_mul_f32 v50, v150, v150
    v_mul_f32 v51, v151, v151
    v_fma_f32 v48, v48, s68, v87
    v_fma_f32 v49, v49, s68, v87
    v_fma_f32 v50, v50, s68, v87
    v_fma_f32 v51, v51, s68, v87
    v_mul_f32 v48, v48, v148
    v_mul_f32 v49, v49, v149
    v_mul_f32 v50, v50, v150
    v_mul_f32 v51, v51, v151
    v_exp_f32 v48, v48
    v_exp_f32 v49, v49
    v_exp_f32 v50, v50
    v_exp_f32 v51, v51
    v_mul_f32 v148, v148, v94
    v_mul_f32 v149, v149, v114
    v_mul_f32 v150, v150, v95
    v_mul_f32 v151, v151, v115
    v_add_f32 v48, 1.0, v48
    v_add_f32 v49, 1.0, v49
    v_add_f32 v50, 1.0, v50
    v_add_f32 v51, 1.0, v51
    v_rcp_f32 v48, v48
    v_rcp_f32 v49, v49
    v_rcp_f32 v50, v50
    v_rcp_f32 v51, v51
    s_nop 0
    v_fmac_f32 v89, v148, v48
    v_fmac_f32 v89, v149, v49
    v_fmac_f32 v89, v150, v50
    v_fmac_f32 v89, v151, v51
    v_mul_f32 v48, v152, v152
    v_mul_f32 v49, v153, v153
    v_mul_f32 v50, v154, v154
    v_mul_f32 v51, v155, v155
    v_fma_f32 v48, v48, s68, v87
    v_fma_f32 v49, v49, s68, v87
    v_fma_f32 v50, v50, s68, v87
    v_fma_f32 v51, v51, s68, v87
    v_mul_f32 v48, v48, v152
    v_mul_f32 v49, v49, v153
    v_mul_f32 v50, v50, v154
    v_mul_f32 v51, v51, v155
    v_exp_f32 v48, v48
    v_exp_f32 v49, v49
    v_exp_f32 v50, v50
    v_exp_f32 v51, v51
    v_mul_f32 v152, v152, v96
    v_mul_f32 v153, v153, v116
    v_mul_f32 v154, v154, v97
    v_mul_f32 v155, v155, v117
    v_add_f32 v48, 1.0, v48
    v_add_f32 v49, 1.0, v49
    v_add_f32 v50, 1.0, v50
    v_add_f32 v51, 1.0, v51
    v_rcp_f32 v48, v48
    v_rcp_f32 v49, v49
    v_rcp_f32 v50, v50
    v_rcp_f32 v51, v51
    s_nop 0
    v_fmac_f32 v89, v152, v48
    v_fmac_f32 v89, v153, v49
    v_fmac_f32 v89, v154, v50
    v_fmac_f32 v89, v155, v51
    v_mul_f32 v48, v156, v156
    v_mul_f32 v49, v157, v157
    v_mul_f32 v50, v158, v158
    v_mul_f32 v51, v159, v159
    v_fma_f32 v48, v48, s68, v87
    v_fma_f32 v49, v49, s68, v87
    v_fma_f32 v50, v50, s68, v87
    v_fma_f32 v51, v51, s68, v87
    v_mul_f32 v48, v48, v156
    v_mul_f32 v49, v49, v157
    v_mul_f32 v50, v50, v158
    v_mul_f32 v51, v51, v159
    v_exp_f32 v48, v48
    v_exp_f32 v49, v49
    v_exp_f32 v50, v50
    v_exp_f32 v51, v51
    v_mul_f32 v156, v156, v98
    v_mul_f32 v157, v157, v118
    v_mul_f32 v158, v158, v99
    v_mul_f32 v159, v159, v119
    v_add_f32 v48, 1.0, v48
    v_add_f32 v49, 1.0, v49
    v_add_f32 v50, 1.0, v50
    v_add_f32 v51, 1.0, v51
    v_rcp_f32 v48, v48
    v_rcp_f32 v49, v49
    v_rcp_f32 v50, v50
    v_rcp_f32 v51, v51
    s_nop 0
    v_fmac_f32 v89, v156, v48
    v_fmac_f32 v89, v157, v49
    v_fmac_f32 v89, v158, v50
    v_fmac_f32 v89, v159, v51
    s_movk_i32 s66, 0xff
    v_add_u32 v120, 1, v120
    v_permlane32_swap_b32 v88, v89
    v_xor_b32 v121, v120, v121
    v_add_f32 v88, v88, v89
    v_mov_b32 v89, v88
    s_lshl_b32 s67, s7, 13
    s_add_u32 s67, s67, 65536
    v_permlane16_swap_b32 v88, v89
    v_add_f32 v88, v88, v89
    v_bfi_b32 v121, s66, v121, v88
    s_mov_b32 exec_lo, 0xffff
    s_mov_b32 exec_hi, 0xffff
    buffer_store_dwordx2 v[120:121], v122, s[52:55], s67 offen sc0 sc1
    s_endpgm
L_help_b:
    s_waitcnt vmcnt(11)
    v_lshlrev_b32 v8, 3, v29
    v_and_b32 v8, 0x70, v8
    v_lshl_or_b32 v29, v29, 7, v8
    v_and_b32 v3, 31, v2
    v_lshlrev_b32 v4, 2, v3
    v_readlane_b32 s76, v29, 0
    v_readlane_b32 s77, v29, 1
    v_readlane_b32 s78, v29, 2
    v_readlane_b32 s79, v29, 3
    v_readlane_b32 s80, v29, 4
    v_readlane_b32 s81, v29, 5
    v_readlane_b32 s82, v29, 6
    v_readlane_b32 s83, v29, 7
    v_readlane_b32 s84, v29, 8
    v_readlane_b32 s85, v29, 9
    v_readlane_b32 s86, v29, 10
    v_readlane_b32 s87, v29, 11
    v_readlane_b32 s88, v29, 12
    v_readlane_b32 s89, v29, 13
    v_readlane_b32 s90, v29, 14
    v_readlane_b32 s91, v29, 15
    v_readlane_b32 s92, v29, 16
    v_readlane_b32 s93, v29, 17
    v_readlane_b32 s94, v29, 18
    v_readlane_b32 s95, v29, 19
    v_readlane_b32 s96, v29, 20
    v_readlane_b32 s97, v29, 21
    v_readlane_b32 s98, v29, 22
    v_readlane_b32 s99, v29, 23
    v_readlane_b32 s100, v29, 24
    v_readlane_b32 s101, v29, 25
    s_mov_b32 exec_hi, 0
    v_xor_b32 v32, s76, v4
    v_xor_b32 v33, s77, v4
    v_xor_b32 v34, s78, v4
    v_xor_b32 v35, s79, v4
    v_xor_b32 v36, s80, v4
    v_xor_b32 v37, s81, v4
    v_xor_b32 v38, s82, v4
    v_xor_b32 v39, s83, v4
    v_xor_b32 v40, s84, v4
    v_xor_b32 v41, s85, v4
    v_xor_b32 v42, s86, v4
    v_xor_b32 v43, s87, v4
    v_xor_b32 v44, s88, v4
    v_xor_b32 v45, s89, v4
    v_xor_b32 v46, s90, v4
    v_xor_b32 v47, s91, v4
    v_xor_b32 v48, s92, v4
    v_xor_b32 v49, s93, v4
    v_xor_b32 v50, s94, v4
    v_xor_b32 v51, s95, v4
    v_xor_b32 v52, s96, v4
    v_xor_b32 v53, s97, v4
    v_xor_b32 v54, s98, v4
    v_xor_b32 v55, s99, v4
    v_xor_b32 v56, s100, v4
    v_xor_b32 v57, s101, v4
    s_mov_b64 exec, -1
    s_mov_b32 exec_lo, 0
    v_xor_b32 v32, s77, v4
    v_xor_b32 v33, s78, v4
    v_xor_b32 v34, s79, v4
    v_xor_b32 v35, s80, v4
    v_xor_b32 v36, s81, v4
    v_xor_b32 v37, s82, v4
    v_xor_b32 v38, s83, v4
    v_xor_b32 v39, s84, v4
    v_xor_b32 v40, s85, v4
    v_xor_b32 v41, s86, v4
    v_xor_b32 v42, s87, v4
    v_xor_b32 v43, s88, v4
    v_xor_b32 v44, s89, v4
    v_xor_b32 v45, s90, v4
    v_xor_b32 v46, s91, v4
    v_xor_b32 v47, s92, v4
    v_xor_b32 v48, s93, v4
    v_xor_b32 v49, s94, v4
    v_xor_b32 v50, s95, v4
    v_xor_b32 v51, s96, v4
    v_xor_b32 v52, s97, v4
    v_xor_b32 v53, s98, v4
    v_xor_b32 v54, s99, v4
    v_xor_b32 v55, s100, v4
    v_xor_b32 v56, s101, v4
    v_xor_b32 v57, s76, v4
    s_mov_b64 exec, -1
    s_waitcnt vmcnt(0)
    s_barrier
    ds_read_b32 v32, v32
    ds_read_b32 v33, v33
    ds_read_b32 v34, v34
    ds_read_b32 v35, v35
    ds_read_b32 v36, v36
    ds_read_b32 v37, v37
    ds_read_b32 v38, v38
    ds_read_b32 v39, v39
    ds_read_b32 v40, v40
    ds_read_b32 v41, v41
    ds_read_b32 v42, v42
    ds_read_b32 v43, v43
    ds_read_b32 v44, v44
    ds_read_b32 v45, v45
    ds_read_b32 v46, v46
    ds_read_b32 v47, v47
    ds_read_b32 v48, v48
    ds_read_b32 v49, v49
    ds_read_b32 v50, v50
    ds_read_b32 v51, v51
    ds_read_b32 v52, v52
    ds_read_b32 v53, v53
    ds_read_b32 v54, v54
    ds_read_b32 v55, v55
    ds_read_b32 v56, v56
    ds_read_b32 v57, v57
    s_branch L_help_main
L_help_x0:
    buffer_load_dword v32, v32, s[44:47], 0 offen
    buffer_load_dword v33, v33, s[44:47], 0 offen
    buffer_load_dword v34, v34, s[44:47], 0 offen
    buffer_load_dword v35, v35, s[44:47], 0 offen
    buffer_load_dword v36, v36, s[44:47], 0 offen
    buffer_load_dword v37, v37, s[44:47], 0 offen
    buffer_load_dword v38, v38, s[44:47], 0 offen
    buffer_load_dword v39, v39, s[44:47], 0 offen
    buffer_load_dword v40, v40, s[44:47], 0 offen
    buffer_load_dword v41, v41, s[44:47], 0 offen
    buffer_load_dword v42, v42, s[44:47], 0 offen
    buffer_load_dword v43, v43, s[44:47], 0 offen
    buffer_load_dword v44, v44, s[44:47], 0 offen
    buffer_load_dword v45, v45, s[44:47], 0 offen
    buffer_load_dword v46, v46, s[44:47], 0 offen
    buffer_load_dword v47, v47, s[44:47], 0 offen
    buffer_load_dword v48, v48, s[44:47], 0 offen
    buffer_load_dword v49, v49, s[44:47], 0 offen
    buffer_load_dword v50, v50, s[44:47], 0 offen
    buffer_load_dword v51, v51, s[44:47], 0 offen
    buffer_load_dword v52, v52, s[44:47], 0 offen
    buffer_load_dword v53, v53, s[44:47], 0 offen
    buffer_load_dword v54, v54, s[44:47], 0 offen
    buffer_load_dword v55, v55, s[44:47], 0 offen
    buffer_load_dword v56, v56, s[44:47], 0 offen
    buffer_load_dword v57, v57, s[44:47], 0 offen
L_help_main:
    s_mov_b32 s52, s36
    s_mov_b32 s53, s37
    s_mov_b32 s54, 2097152
    s_mov_b32 s55, 0x20000
    s_mov_b32 s56, s34
    s_mov_b32 s57, s35
    s_mov_b32 s58, 256
    s_mov_b32 s59, 0x20000
    s_mov_b32 s60, s32
    s_mov_b32 s61, s33
    s_mov_b32 s62, 2048
    s_mov_b32 s63, 0x20000
    v_lshrrev_b32 v5, 2, v3
    v_mul_u32_u24 v5, 5888, v5
    v_and_b32 v6, 3, v2
    v_lshl_add_u32 v5, v6, 4, v5
    v_lshrrev_b32 v6, 5, v2
    v_lshl_add_u32 v5, v6, 6, v5
    v_mov_b32 v7, 0x7fff0000
    v_cmp_gt_u32 vcc, 26, v3
    v_lshlrev_b32 v6, 13, v2
    s_lshl_b32 s66, s6, 3
    v_cndmask_b32 v5, v7, v5, vcc
    s_add_u32 s66, s66, 65536
    v_add_u32 v6, s66, v6
    v_cmp_gt_u32 vcc, 26, v2
    v_lshlrev_b32 v1, 4, v2
    v_add_u32 v1, 97280, v1
    v_cndmask_b32 v6, v7, v6, vcc
    v_mov_b32 v7, 160768
    s_waitcnt vmcnt(0) lgkmcnt(0)
    s_lshl_b32 s74, s6, 3
    s_add_u32 s74, s74, 327680
    s_load_dwordx2 s[38:39], s[36:37], s74
    s_load_dword s9, s[30:31], 0
    v_lshlrev_b32 v200, 16, v32
    v_and_b32 v201, 0xffff0000, v32
    v_lshlrev_b32 v202, 16, v33
    v_and_b32 v203, 0xffff0000, v33
    v_lshlrev_b32 v204, 16, v34
    v_and_b32 v205, 0xffff0000, v34
    v_lshlrev_b32 v206, 16, v35
    v_and_b32 v207, 0xffff0000, v35
    v_lshlrev_b32 v208, 16, v36
    v_and_b32 v209, 0xffff0000, v36
    v_lshlrev_b32 v210, 16, v37
    v_and_b32 v211, 0xffff0000, v37
    v_lshlrev_b32 v212, 16, v38
    v_and_b32 v213, 0xffff0000, v38
    v_lshlrev_b32 v214, 16, v39
    v_and_b32 v215, 0xffff0000, v39
    v_lshlrev_b32 v216, 16, v40
    v_and_b32 v217, 0xffff0000, v40
    v_lshlrev_b32 v218, 16, v41
    v_and_b32 v219, 0xffff0000, v41
    v_lshlrev_b32 v220, 16, v42
    v_and_b32 v221, 0xffff0000, v42
    v_lshlrev_b32 v222, 16, v43
    v_and_b32 v223, 0xffff0000, v43
    v_lshlrev_b32 v224, 16, v44
    v_and_b32 v225, 0xffff0000, v44
    v_lshlrev_b32 v226, 16, v45
    v_and_b32 v227, 0xffff0000, v45
    v_lshlrev_b32 v228, 16, v46
    v_and_b32 v229, 0xffff0000, v46
    v_lshlrev_b32 v230, 16, v47
    v_and_b32 v231, 0xffff0000, v47
    v_lshlrev_b32 v232, 16, v48
    v_and_b32 v233, 0xffff0000, v48
    v_lshlrev_b32 v234, 16, v49
    v_and_b32 v235, 0xffff0000, v49
    v_lshlrev_b32 v236, 16, v50
    v_and_b32 v237, 0xffff0000, v50
    v_lshlrev_b32 v238, 16, v51
    v_and_b32 v239, 0xffff0000, v51
    v_lshlrev_b32 v240, 16, v52
    v_and_b32 v241, 0xffff0000, v52
    v_lshlrev_b32 v242, 16, v53
    v_and_b32 v243, 0xffff0000, v53
    v_lshlrev_b32 v244, 16, v54
    v_and_b32 v245, 0xffff0000, v54
    v_lshlrev_b32 v246, 16, v55
    v_and_b32 v247, 0xffff0000, v55
    v_lshlrev_b32 v248, 16, v56
    v_and_b32 v249, 0xffff0000, v56
    v_lshlrev_b32 v250, 16, v57
    v_and_b32 v251, 0xffff0000, v57
    v_cvt_pk_bf16_f32 v184, v200, v204
    v_cvt_pk_bf16_f32 v192, v201, v205
    v_cvt_pk_bf16_f32 v185, v208, v212
    v_cvt_pk_bf16_f32 v193, v209, v213
    v_cvt_pk_bf16_f32 v186, v216, v220
    v_cvt_pk_bf16_f32 v194, v217, v221
    v_cvt_pk_bf16_f32 v187, v224, v228
    v_cvt_pk_bf16_f32 v195, v225, v229
    v_cvt_pk_bf16_f32 v188, v232, v236
    v_cvt_pk_bf16_f32 v196, v233, v237
    v_cvt_pk_bf16_f32 v189, v240, v244
    v_cvt_pk_bf16_f32 v197, v241, v245
    v_cvt_pk_bf16_f32 v190, v248, 1.0
    v_cvt_pk_bf16_f32 v198, v249, 1.0
    v_mov_b32 v191, 0
    v_mov_b32 v199, 0
    v_mul_f32 v252, v200, v200
    v_mul_f32 v254, v204, v204
    v_mul_f32 v253, v201, v201
    v_mul_f32 v255, v205, v205
    v_cvt_pk_bf16_f32 v8, v252, v254
    v_cvt_pk_bf16_f32 v96, v253, v255
    v_mul_f32 v252, v208, v208
    v_mul_f32 v254, v212, v212
    v_mul_f32 v253, v209, v209
    v_mul_f32 v255, v213, v213
    v_cvt_pk_bf16_f32 v9, v252, v254
    v_cvt_pk_bf16_f32 v97, v253, v255
    v_mul_f32 v252, v216, v216
    v_mul_f32 v254, v220, v220
    v_mul_f32 v253, v217, v217
    v_mul_f32 v255, v221, v221
    v_cvt_pk_bf16_f32 v10, v252, v254
    v_cvt_pk_bf16_f32 v98, v253, v255
    v_mul_f32 v252, v224, v224
    v_mul_f32 v254, v228, v228
    v_mul_f32 v253, v225, v225
    v_mul_f32 v255, v229, v229
    v_cvt_pk_bf16_f32 v11, v252, v254
    v_cvt_pk_bf16_f32 v99, v253, v255
    v_mul_f32 v252, v232, v232
    v_mul_f32 v254, v236, v236
    v_mul_f32 v253, v233, v233
    v_mul_f32 v255, v237, v237
    v_cvt_pk_bf16_f32 v12, v252, v254
    v_cvt_pk_bf16_f32 v100, v253, v255
    v_mul_f32 v252, v240, v240
    v_mul_f32 v254, v244, v244
    v_mul_f32 v253, v241, v241
    v_mul_f32 v255, v245, v245
    v_cvt_pk_bf16_f32 v13, v252, v254
    v_cvt_pk_bf16_f32 v101, v253, v255
    v_mul_f32 v252, v248, v248
    v_mul_f32 v254, v200, v202
    v_mul_f32 v253, v249, v249
    v_mul_f32 v255, v201, v203
    v_cvt_pk_bf16_f32 v14, v252, v254
    v_cvt_pk_bf16_f32 v102, v253, v255
    v_mul_f32 v252, v204, v206
    v_mul_f32 v254, v208, v210
    v_mul_f32 v253, v205, v207
    v_mul_f32 v255, v209, v211
    v_cvt_pk_bf16_f32 v15, v252, v254
    v_cvt_pk_bf16_f32 v103, v253, v255
    v_mul_f32 v252, v212, v214
    v_mul_f32 v254, v216, v218
    v_mul_f32 v253, v213, v215
    v_mul_f32 v255, v217, v219
    v_cvt_pk_bf16_f32 v16, v252, v254
    v_cvt_pk_bf16_f32 v104, v253, v255
    v_mul_f32 v252, v220, v222
    v_mul_f32 v254, v224, v226
    v_mul_f32 v253, v221, v223
    v_mul_f32 v255, v225, v227
    v_cvt_pk_bf16_f32 v17, v252, v254
    v_cvt_pk_bf16_f32 v105, v253, v255
    v_mul_f32 v252, v228, v230
    v_mul_f32 v254, v232, v234
    v_mul_f32 v253, v229, v231
    v_mul_f32 v255, v233, v235
    v_cvt_pk_bf16_f32 v18, v252, v254
    v_cvt_pk_bf16_f32 v106, v253, v255
    v_mul_f32 v252, v236, v238
    v_mul_f32 v254, v240, v242
    v_mul_f32 v253, v237, v239
    v_mul_f32 v255, v241, v243
    v_cvt_pk_bf16_f32 v19, v252, v254
    v_cvt_pk_bf16_f32 v107, v253, v255
    v_mul_f32 v252, v244, v246
    v_mul_f32 v254, v248, v250
    v_mul_f32 v253, v245, v247
    v_mul_f32 v255, v249, v251
    v_cvt_pk_bf16_f32 v20, v252, v254
    v_cvt_pk_bf16_f32 v108, v253, v255
    v_mul_f32 v252, v200, v204
    v_mul_f32 v254, v204, v208
    v_mul_f32 v253, v201, v205
    v_mul_f32 v255, v205, v209
    v_cvt_pk_bf16_f32 v21, v252, v254
    v_cvt_pk_bf16_f32 v109, v253, v255
    v_mul_f32 v252, v208, v212
    v_mul_f32 v254, v212, v216
    v_mul_f32 v253, v209, v213
    v_mul_f32 v255, v213, v217
    v_cvt_pk_bf16_f32 v22, v252, v254
    v_cvt_pk_bf16_f32 v110, v253, v255
    v_mul_f32 v252, v216, v220
    v_mul_f32 v254, v220, v224
    v_mul_f32 v253, v217, v221
    v_mul_f32 v255, v221, v225
    v_cvt_pk_bf16_f32 v23, v252, v254
    v_cvt_pk_bf16_f32 v111, v253, v255
    v_mul_f32 v252, v224, v228
    v_mul_f32 v254, v228, v232
    v_mul_f32 v253, v225, v229
    v_mul_f32 v255, v229, v233
    v_cvt_pk_bf16_f32 v24, v252, v254
    v_cvt_pk_bf16_f32 v112, v253, v255
    v_mul_f32 v252, v232, v236
    v_mul_f32 v254, v236, v240
    v_mul_f32 v253, v233, v237
    v_mul_f32 v255, v237, v241
    v_cvt_pk_bf16_f32 v25, v252, v254
    v_cvt_pk_bf16_f32 v113, v253, v255
    v_mul_f32 v252, v240, v244
    v_mul_f32 v254, v244, v248
    v_mul_f32 v253, v241, v245
    v_mul_f32 v255, v245, v249
    v_cvt_pk_bf16_f32 v26, v252, v254
    v_cvt_pk_bf16_f32 v114, v253, v255
    v_mul_f32 v252, v248, v200
    v_mul_f32 v254, v200, v206
    v_mul_f32 v253, v249, v201
    v_mul_f32 v255, v201, v207
    v_cvt_pk_bf16_f32 v27, v252, v254
    v_cvt_pk_bf16_f32 v115, v253, v255
    v_mul_f32 v252, v204, v210
    v_mul_f32 v254, v208, v214
    v_mul_f32 v253, v205, v211
    v_mul_f32 v255, v209, v215
    v_cvt_pk_bf16_f32 v28, v252, v254
    v_cvt_pk_bf16_f32 v116, v253, v255
    v_mul_f32 v252, v212, v218
    v_mul_f32 v254, v216, v222
    v_mul_f32 v253, v213, v219
    v_mul_f32 v255, v217, v223
    v_cvt_pk_bf16_f32 v29, v252, v254
    v_cvt_pk_bf16_f32 v117, v253, v255
    v_mul_f32 v252, v220, v226
    v_mul_f32 v254, v224, v230
    v_mul_f32 v253, v221, v227
    v_mul_f32 v255, v225, v231
    v_cvt_pk_bf16_f32 v30, v252, v254
    v_cvt_pk_bf16_f32 v118, v253, v255
    v_mul_f32 v252, v228, v234
    v_mul_f32 v254, v232, v238
    v_mul_f32 v253, v229, v235
    v_mul_f32 v255, v233, v239
    v_cvt_pk_bf16_f32 v31, v252, v254
    v_cvt_pk_bf16_f32 v119, v253, v255
    v_mul_f32 v252, v236, v242
    v_mul_f32 v254, v240, v246
    v_mul_f32 v253, v237, v243
    v_mul_f32 v255, v241, v247
    v_cvt_pk_bf16_f32 v32, v252, v254
    v_cvt_pk_bf16_f32 v120, v253, v255
    v_mul_f32 v252, v244, v250
    v_mul_f32 v254, v248, v202
    v_mul_f32 v253, v245, v251
    v_mul_f32 v255, v249, v203
    v_cvt_pk_bf16_f32 v33, v252, v254
    v_cvt_pk_bf16_f32 v121, v253, v255
    v_mul_f32 v252, v200, v208
    v_mul_f32 v254, v204, v212
    v_mul_f32 v253, v201, v209
    v_mul_f32 v255, v205, v213
    v_cvt_pk_bf16_f32 v34, v252, v254
    v_cvt_pk_bf16_f32 v122, v253, v255
    v_mul_f32 v252, v208, v216
    v_mul_f32 v254, v212, v220
    v_mul_f32 v253, v209, v217
    v_mul_f32 v255, v213, v221
    v_cvt_pk_bf16_f32 v35, v252, v254
    v_cvt_pk_bf16_f32 v123, v253, v255
    v_mul_f32 v252, v216, v224
    v_mul_f32 v254, v220, v228
    v_mul_f32 v253, v217, v225
    v_mul_f32 v255, v221, v229
    v_cvt_pk_bf16_f32 v36, v252, v254
    v_cvt_pk_bf16_f32 v124, v253, v255
    v_mul_f32 v252, v224, v232
    v_mul_f32 v254, v228, v236
    v_mul_f32 v253, v225, v233
    v_mul_f32 v255, v229, v237
    v_cvt_pk_bf16_f32 v37, v252, v254
    v_cvt_pk_bf16_f32 v125, v253, v255
    v_mul_f32 v252, v232, v240
    v_mul_f32 v254, v236, v244
    v_mul_f32 v253, v233, v241
    v_mul_f32 v255, v237, v245
    v_cvt_pk_bf16_f32 v38, v252, v254
    v_cvt_pk_bf16_f32 v126, v253, v255
    v_mul_f32 v252, v240, v248
    v_mul_f32 v254, v244, v200
    v_mul_f32 v253, v241, v249
    v_mul_f32 v255, v245, v201
    v_cvt_pk_bf16_f32 v39, v252, v254
    v_cvt_pk_bf16_f32 v127, v253, v255
    v_mul_f32 v252, v248, v204
    v_mul_f32 v254, v200, v210
    v_mul_f32 v253, v249, v205
    v_mul_f32 v255, v201, v211
    v_cvt_pk_bf16_f32 v40, v252, v254
    v_cvt_pk_bf16_f32 v128, v253, v255
    v_mul_f32 v252, v204, v214
    v_mul_f32 v254, v208, v218
    v_mul_f32 v253, v205, v215
    v_mul_f32 v255, v209, v219
    v_cvt_pk_bf16_f32 v41, v252, v254
    v_cvt_pk_bf16_f32 v129, v253, v255
    v_mul_f32 v252, v212, v222
    v_mul_f32 v254, v216, v226
    v_mul_f32 v253, v213, v223
    v_mul_f32 v255, v217, v227
    v_cvt_pk_bf16_f32 v42, v252, v254
    v_cvt_pk_bf16_f32 v130, v253, v255
    v_mul_f32 v252, v220, v230
    v_mul_f32 v254, v224, v234
    v_mul_f32 v253, v221, v231
    v_mul_f32 v255, v225, v235
    v_cvt_pk_bf16_f32 v43, v252, v254
    v_cvt_pk_bf16_f32 v131, v253, v255
    v_mul_f32 v252, v228, v238
    v_mul_f32 v254, v232, v242
    v_mul_f32 v253, v229, v239
    v_mul_f32 v255, v233, v243
    v_cvt_pk_bf16_f32 v44, v252, v254
    v_cvt_pk_bf16_f32 v132, v253, v255
    v_mul_f32 v252, v236, v246
    v_mul_f32 v254, v240, v250
    v_mul_f32 v253, v237, v247
    v_mul_f32 v255, v241, v251
    v_cvt_pk_bf16_f32 v45, v252, v254
    v_cvt_pk_bf16_f32 v133, v253, v255
    v_mul_f32 v252, v244, v202
    v_mul_f32 v254, v248, v206
    v_mul_f32 v253, v245, v203
    v_mul_f32 v255, v249, v207
    v_cvt_pk_bf16_f32 v46, v252, v254
    v_cvt_pk_bf16_f32 v134, v253, v255
    v_mul_f32 v252, v200, v212
    v_mul_f32 v254, v204, v216
    v_mul_f32 v253, v201, v213
    v_mul_f32 v255, v205, v217
    v_cvt_pk_bf16_f32 v47, v252, v254
    v_cvt_pk_bf16_f32 v135, v253, v255
    v_mul_f32 v252, v208, v220
    v_mul_f32 v254, v212, v224
    v_mul_f32 v253, v209, v221
    v_mul_f32 v255, v213, v225
    v_cvt_pk_bf16_f32 v48, v252, v254
    v_cvt_pk_bf16_f32 v136, v253, v255
    v_mul_f32 v252, v216, v228
    v_mul_f32 v254, v220, v232
    v_mul_f32 v253, v217, v229
    v_mul_f32 v255, v221, v233
    v_cvt_pk_bf16_f32 v49, v252, v254
    v_cvt_pk_bf16_f32 v137, v253, v255
    v_mul_f32 v252, v224, v236
    v_mul_f32 v254, v228, v240
    v_mul_f32 v253, v225, v237
    v_mul_f32 v255, v229, v241
    v_cvt_pk_bf16_f32 v50, v252, v254
    v_cvt_pk_bf16_f32 v138, v253, v255
    v_mul_f32 v252, v232, v244
    v_mul_f32 v254, v236, v248
    v_mul_f32 v253, v233, v245
    v_mul_f32 v255, v237, v249
    v_cvt_pk_bf16_f32 v51, v252, v254
    v_cvt_pk_bf16_f32 v139, v253, v255
    v_mul_f32 v252, v240, v200
    v_mul_f32 v254, v244, v204
    v_mul_f32 v253, v241, v201
    v_mul_f32 v255, v245, v205
    v_cvt_pk_bf16_f32 v52, v252, v254
    v_cvt_pk_bf16_f32 v140, v253, v255
    v_mul_f32 v252, v248, v208
    v_mul_f32 v254, v200, v214
    v_mul_f32 v253, v249, v209
    v_mul_f32 v255, v201, v215
    v_cvt_pk_bf16_f32 v53, v252, v254
    v_cvt_pk_bf16_f32 v141, v253, v255
    v_mul_f32 v252, v204, v218
    v_mul_f32 v254, v208, v222
    v_mul_f32 v253, v205, v219
    v_mul_f32 v255, v209, v223
    v_cvt_pk_bf16_f32 v54, v252, v254
    v_cvt_pk_bf16_f32 v142, v253, v255
    v_mul_f32 v252, v212, v226
    v_mul_f32 v254, v216, v230
    v_mul_f32 v253, v213, v227
    v_mul_f32 v255, v217, v231
    v_cvt_pk_bf16_f32 v55, v252, v254
    v_cvt_pk_bf16_f32 v143, v253, v255
    v_mul_f32 v252, v220, v234
    v_mul_f32 v254, v224, v238
    v_mul_f32 v253, v221, v235
    v_mul_f32 v255, v225, v239
    v_cvt_pk_bf16_f32 v56, v252, v254
    v_cvt_pk_bf16_f32 v144, v253, v255
    v_mul_f32 v252, v228, v242
    v_mul_f32 v254, v232, v246
    v_mul_f32 v253, v229, v243
    v_mul_f32 v255, v233, v247
    v_cvt_pk_bf16_f32 v57, v252, v254
    v_cvt_pk_bf16_f32 v145, v253, v255
    v_mul_f32 v252, v236, v250
    v_mul_f32 v254, v240, v202
    v_mul_f32 v253, v237, v251
    v_mul_f32 v255, v241, v203
    v_cvt_pk_bf16_f32 v58, v252, v254
    v_cvt_pk_bf16_f32 v146, v253, v255
    v_mul_f32 v252, v244, v206
    v_mul_f32 v254, v248, v210
    v_mul_f32 v253, v245, v207
    v_mul_f32 v255, v249, v211
    v_cvt_pk_bf16_f32 v59, v252, v254
    v_cvt_pk_bf16_f32 v147, v253, v255
    v_mul_f32 v252, v200, v216
    v_mul_f32 v254, v204, v220
    v_mul_f32 v253, v201, v217
    v_mul_f32 v255, v205, v221
    v_cvt_pk_bf16_f32 v60, v252, v254
    v_cvt_pk_bf16_f32 v148, v253, v255
    v_mul_f32 v252, v208, v224
    v_mul_f32 v254, v212, v228
    v_mul_f32 v253, v209, v225
    v_mul_f32 v255, v213, v229
    v_cvt_pk_bf16_f32 v61, v252, v254
    v_cvt_pk_bf16_f32 v149, v253, v255
    v_mul_f32 v252, v216, v232
    v_mul_f32 v254, v220, v236
    v_mul_f32 v253, v217, v233
    v_mul_f32 v255, v221, v237
    v_cvt_pk_bf16_f32 v62, v252, v254
    v_cvt_pk_bf16_f32 v150, v253, v255
    v_mul_f32 v252, v224, v240
    v_mul_f32 v254, v228, v244
    v_mul_f32 v253, v225, v241
    v_mul_f32 v255, v229, v245
    v_cvt_pk_bf16_f32 v63, v252, v254
    v_cvt_pk_bf16_f32 v151, v253, v255
    v_mul_f32 v252, v232, v248
    v_mul_f32 v254, v236, v200
    v_mul_f32 v253, v233, v249
    v_mul_f32 v255, v237, v201
    v_cvt_pk_bf16_f32 v64, v252, v254
    v_cvt_pk_bf16_f32 v152, v253, v255
    v_mul_f32 v252, v240, v204
    v_mul_f32 v254, v244, v208
    v_mul_f32 v253, v241, v205
    v_mul_f32 v255, v245, v209
    v_cvt_pk_bf16_f32 v65, v252, v254
    v_cvt_pk_bf16_f32 v153, v253, v255
    v_mul_f32 v252, v248, v212
    v_mul_f32 v254, v200, v218
    v_mul_f32 v253, v249, v213
    v_mul_f32 v255, v201, v219
    v_cvt_pk_bf16_f32 v66, v252, v254
    v_cvt_pk_bf16_f32 v154, v253, v255
    v_mul_f32 v252, v204, v222
    v_mul_f32 v254, v208, v226
    v_mul_f32 v253, v205, v223
    v_mul_f32 v255, v209, v227
    v_cvt_pk_bf16_f32 v67, v252, v254
    v_cvt_pk_bf16_f32 v155, v253, v255
    s_load_dwordx8 s[92:99], s[34:35], 0
    s_waitcnt lgkmcnt(0)
    s_and_b32 s92, s92, s93
    s_and_b32 s92, s92, s94
    s_and_b32 s92, s92, s95
    s_and_b32 s92, s92, s96
    s_and_b32 s92, s92, s97
    s_and_b32 s92, s92, s98
    s_cmp_lg_u32 s92, 0
    s_cbranch_scc1 L_polled
    s_mov_b32 s70, 16000000
L_it9:
    ds_read_b32 v4, v7 offset:16
    s_waitcnt lgkmcnt(0)
    v_readfirstlane_b32 s71, v4
    s_cmp_ge_u32 s71, 4
    s_cbranch_scc1 L_it9_x
    s_sleep 4
    s_sub_u32 s70, s70, 1
    s_cbranch_scc0 L_it9
L_it9_x:
    v_lshlrev_b32 v0, 2, v2
    buffer_load_dword v4, v0, s[56:59], 0 offen sc1
    s_mov_b32 s70, 2000000
    s_mov_b32 s68, 0x7f
    s_mov_b32 s69, 0
L_poll1:
    s_waitcnt vmcnt(0)
    v_cmp_ne_u32 vcc, 0, v4
    s_and_b64 vcc, vcc, s[68:69]
    s_cmp_eq_u64 vcc, s[68:69]
    s_cbranch_scc1 L_polled
    s_sleep 4
    buffer_load_dword v4, v0, s[56:59], 0 offen sc1
    s_sub_u32 s70, s70, 1
    s_cbranch_scc0 L_poll1
L_polled:
    s_mov_b32 s70, 16000000
L_s1:
    ds_read_b32 v0, v7 offset:16
    s_waitcnt lgkmcnt(0)
    v_readfirstlane_b32 s71, v0
    s_cmp_ge_u32 s71, 4
    s_cbranch_scc1 L_s1_x
    s_sleep 2
    s_sub_u32 s70, s70, 1
    s_cbranch_scc0 L_s1
L_s1_x:
    s_sub_u32 s66, s3, 4
    s_lshl_b32 s67, s66, 13
    s_add_u32 m0, s67, 132096
    s_lshl_b32 s66, s66, 9
    s_sub_u32 s66, s66, 256
    s_cmp_eq_u32 s3, 4
    s_cselect_b32 s67, 5632, s66
    buffer_load_dwordx4 v5, s[52:55], s67 offen sc1 lds
    s_add_u32 m0, m0, 1024
    s_add_u32 s66, s66, 128
    s_cmp_eq_u32 s3, 4
    s_cselect_b32 s67, 5760, s66
    buffer_load_dwordx4 v5, s[52:55], s67 offen sc1 lds
    s_add_u32 m0, m0, 1024
    s_add_u32 s66, s66, 128
    s_mov_b32 s67, s66
    buffer_load_dwordx4 v5, s[52:55], s67 offen sc1 lds
    s_add_u32 m0, m0, 1024
    s_add_u32 s66, s66, 128
    s_mov_b32 s67, s66
    buffer_load_dwordx4 v5, s[52:55], s67 offen sc1 lds
    v_mul_f32 v252, v212, v230
    v_mul_f32 v254, v216, v234
    v_mul_f32 v253, v213, v231
    v_mul_f32 v255, v217, v235
    v_cvt_pk_bf16_f32 v68, v252, v254
    v_cvt_pk_bf16_f32 v156, v253, v255
    v_mul_f32 v252, v220, v238
    v_mul_f32 v254, v224, v242
    v_mul_f32 v253, v221, v239
    v_mul_f32 v255, v225, v243
    v_cvt_pk_bf16_f32 v69, v252, v254
    v_cvt_pk_bf16_f32 v157, v253, v255
    v_mul_f32 v252, v228, v246
    v_mul_f32 v254, v232, v250
    v_mul_f32 v253, v229, v247
    v_mul_f32 v255, v233, v251
    v_cvt_pk_bf16_f32 v70, v252, v254
    v_cvt_pk_bf16_f32 v158, v253, v255
    v_mul_f32 v252, v236, v202
    v_mul_f32 v254, v240, v206
    v_mul_f32 v253, v237, v203
    v_mul_f32 v255, v241, v207
    v_cvt_pk_bf16_f32 v71, v252, v254
    v_cvt_pk_bf16_f32 v159, v253, v255
    v_mul_f32 v252, v244, v210
    v_mul_f32 v254, v248, v214
    v_mul_f32 v253, v245, v211
    v_mul_f32 v255, v249, v215
    v_cvt_pk_bf16_f32 v72, v252, v254
    v_cvt_pk_bf16_f32 v160, v253, v255
    v_mul_f32 v252, v200, v220
    v_mul_f32 v254, v204, v224
    v_mul_f32 v253, v201, v221
    v_mul_f32 v255, v205, v225
    v_cvt_pk_bf16_f32 v73, v252, v254
    v_cvt_pk_bf16_f32 v161, v253, v255
    v_mul_f32 v252, v208, v228
    v_mul_f32 v254, v212, v232
    v_mul_f32 v253, v209, v229
    v_mul_f32 v255, v213, v233
    v_cvt_pk_bf16_f32 v74, v252, v254
    v_cvt_pk_bf16_f32 v162, v253, v255
    v_mul_f32 v252, v216, v236
    v_mul_f32 v254, v220, v240
    v_mul_f32 v253, v217, v237
    v_mul_f32 v255, v221, v241
    v_cvt_pk_bf16_f32 v75, v252, v254
    v_cvt_pk_bf16_f32 v163, v253, v255
    s_waitcnt vmcnt(0)
    s_barrier
    v_mul_f32 v252, v224, v244
    v_mul_f32 v254, v228, v248
    v_mul_f32 v253, v225, v245
    v_mul_f32 v255, v229, v249
    v_cvt_pk_bf16_f32 v76, v252, v254
    v_cvt_pk_bf16_f32 v164, v253, v255
    v_mul_f32 v252, v232, v200
    v_mul_f32 v254, v236, v204
    v_mul_f32 v253, v233, v201
    v_mul_f32 v255, v237, v205
    v_cvt_pk_bf16_f32 v77, v252, v254
    v_cvt_pk_bf16_f32 v165, v253, v255
    v_mul_f32 v252, v240, v208
    v_mul_f32 v254, v244, v212
    v_mul_f32 v253, v241, v209
    v_mul_f32 v255, v245, v213
    v_cvt_pk_bf16_f32 v78, v252, v254
    v_cvt_pk_bf16_f32 v166, v253, v255
    v_mul_f32 v252, v248, v216
    v_mul_f32 v254, v200, v222
    v_mul_f32 v253, v249, v217
    v_mul_f32 v255, v201, v223
    v_cvt_pk_bf16_f32 v79, v252, v254
    v_cvt_pk_bf16_f32 v167, v253, v255
    v_mul_f32 v252, v204, v226
    v_mul_f32 v254, v208, v230
    v_mul_f32 v253, v205, v227
    v_mul_f32 v255, v209, v231
    v_cvt_pk_bf16_f32 v80, v252, v254
    v_cvt_pk_bf16_f32 v168, v253, v255
    v_mul_f32 v252, v212, v234
    v_mul_f32 v254, v216, v238
    v_mul_f32 v253, v213, v235
    v_mul_f32 v255, v217, v239
    v_cvt_pk_bf16_f32 v81, v252, v254
    v_cvt_pk_bf16_f32 v169, v253, v255
    v_mul_f32 v252, v220, v242
    v_mul_f32 v254, v224, v246
    v_mul_f32 v253, v221, v243
    v_mul_f32 v255, v225, v247
    v_cvt_pk_bf16_f32 v82, v252, v254
    v_cvt_pk_bf16_f32 v170, v253, v255
    v_mul_f32 v252, v228, v250
    v_mul_f32 v254, v232, v202
    v_mul_f32 v253, v229, v251
    v_mul_f32 v255, v233, v203
    v_cvt_pk_bf16_f32 v83, v252, v254
    v_cvt_pk_bf16_f32 v171, v253, v255
    v_mul_f32 v252, v236, v206
    v_mul_f32 v254, v240, v210
    v_mul_f32 v253, v237, v207
    v_mul_f32 v255, v241, v211
    v_cvt_pk_bf16_f32 v84, v252, v254
    v_cvt_pk_bf16_f32 v172, v253, v255
    v_mul_f32 v252, v244, v214
    v_mul_f32 v254, v248, v218
    v_mul_f32 v253, v245, v215
    v_mul_f32 v255, v249, v219
    v_cvt_pk_bf16_f32 v85, v252, v254
    v_cvt_pk_bf16_f32 v173, v253, v255
    v_mul_f32 v252, v200, v224
    v_mul_f32 v254, v204, v228
    v_mul_f32 v253, v201, v225
    v_mul_f32 v255, v205, v229
    v_cvt_pk_bf16_f32 v86, v252, v254
    v_cvt_pk_bf16_f32 v174, v253, v255
    v_mul_f32 v252, v208, v232
    v_mul_f32 v254, v212, v236
    v_mul_f32 v253, v209, v233
    v_mul_f32 v255, v213, v237
    v_cvt_pk_bf16_f32 v87, v252, v254
    v_cvt_pk_bf16_f32 v175, v253, v255
    v_mul_f32 v252, v216, v240
    v_mul_f32 v254, v220, v244
    v_mul_f32 v253, v217, v241
    v_mul_f32 v255, v221, v245
    v_cvt_pk_bf16_f32 v88, v252, v254
    v_cvt_pk_bf16_f32 v176, v253, v255
    v_mul_f32 v252, v224, v248
    v_mul_f32 v254, v228, v200
    v_mul_f32 v253, v225, v249
    v_mul_f32 v255, v229, v201
    v_cvt_pk_bf16_f32 v89, v252, v254
    v_cvt_pk_bf16_f32 v177, v253, v255
    v_mul_f32 v252, v232, v204
    v_mul_f32 v254, v236, v208
    v_mul_f32 v253, v233, v205
    v_mul_f32 v255, v237, v209
    v_cvt_pk_bf16_f32 v90, v252, v254
    v_cvt_pk_bf16_f32 v178, v253, v255
    v_mul_f32 v252, v240, v212
    v_mul_f32 v254, v244, v216
    v_mul_f32 v253, v241, v213
    v_mul_f32 v255, v245, v217
    v_cvt_pk_bf16_f32 v91, v252, v254
    v_cvt_pk_bf16_f32 v179, v253, v255
    v_mul_f32 v252, v248, v220
    v_mul_f32 v254, v200, v226
    v_mul_f32 v253, v249, v221
    v_mul_f32 v255, v201, v227
    v_cvt_pk_bf16_f32 v92, v252, v254
    v_cvt_pk_bf16_f32 v180, v253, v255
    v_mul_f32 v252, v204, v230
    v_mul_f32 v254, v208, v234
    v_mul_f32 v253, v205, v231
    v_mul_f32 v255, v209, v235
    v_cvt_pk_bf16_f32 v93, v252, v254
    v_cvt_pk_bf16_f32 v181, v253, v255
    v_mul_f32 v252, v212, v238
    v_mul_f32 v254, v216, v242
    v_mul_f32 v253, v213, v239
    v_mul_f32 v255, v217, v243
    v_cvt_pk_bf16_f32 v94, v252, v254
    v_cvt_pk_bf16_f32 v182, v253, v255
    v_mul_f32 v252, v220, v246
    v_mul_f32 v254, v224, v250
    v_mul_f32 v253, v221, v247
    v_mul_f32 v255, v225, v251
    v_cvt_pk_bf16_f32 v95, v252, v254
    v_cvt_pk_bf16_f32 v183, v253, v255
    s_sub_u32 s66, s3, 4
    s_lshl_b32 s67, s66, 10
    s_add_u32 s67, s67, 97280
    s_lshl_b32 s66, s66, 7
    s_add_u32 s66, s66, 1792
    s_cmp_ge_u32 s3, 6
    s_cselect_b32 s74, 6, 7
    s_lshl_b32 s74, s74, 9
    s_mov_b32 s70, 16000000
L_gC:
    ds_read_b32 v0, v7 offset:4
    s_waitcnt lgkmcnt(0)
    v_readfirstlane_b32 s71, v0
    s_cmp_ge_u32 s71, 4
    s_cbranch_scc1 L_gC_x
    s_sleep 1
    s_sub_u32 s70, s70, 1
    s_cbranch_scc0 L_gC
L_gC_x:
    ds_read_b128 v[232:235], v1 offset:34816
    ds_read_b128 v[236:239], v1 offset:35840
    ds_read_b128 v[240:243], v1 offset:36864
    ds_read_b128 v[244:247], v1 offset:37888
    s_add_u32 m0, s67, 0
    s_add_u32 s75, s66, 0
    buffer_load_dwordx4 v5, s[52:55], s75 offen sc1 lds
    s_add_u32 m0, s67, 4096
    s_add_u32 s75, s66, 512
    buffer_load_dwordx4 v5, s[52:55], s75 offen sc1 lds
    s_waitcnt lgkmcnt(3)
    v_mfma_f32_32x32x16_bf16 v[200:215], v[232:235], v[184:187], 0
    s_add_u32 m0, s67, 8192
    s_add_u32 s75, s66, 1024
    buffer_load_dwordx4 v5, s[52:55], s75 offen sc1 lds
    v_mfma_f32_32x32x16_bf16 v[216:231], v[232:235], v[192:195], 0
    s_add_u32 m0, s67, 12288
    s_add_u32 s75, s66, 1536
    buffer_load_dwordx4 v5, s[52:55], s75 offen sc1 lds
    s_waitcnt lgkmcnt(2)
    v_mfma_f32_32x32x16_bf16 v[200:215], v[236:239], v[188:191], v[200:215]
    s_add_u32 m0, s67, 16384
    s_add_u32 s75, s66, 2048
    buffer_load_dwordx4 v5, s[52:55], s75 offen sc1 lds
    ds_read_b128 v[248:251], v1 offset:43008
    v_mfma_f32_32x32x16_bf16 v[216:231], v[236:239], v[196:199], v[216:231]
    s_add_u32 m0, s67, 20480
    s_add_u32 s75, s66, 2560
    buffer_load_dwordx4 v5, s[52:55], s75 offen sc1 lds
    ds_read_b128 v[252:255], v1 offset:44032
    s_waitcnt lgkmcnt(2)
    v_mfma_f32_32x32x16_bf16 v[184:199], v[240:243], v[8:11], 0
    s_add_u32 m0, s67, 24576
    s_add_u32 s75, s66, 3072
    buffer_load_dwordx4 v5, s[52:55], s75 offen sc1 lds
    ds_read_b128 v[232:235], v1 offset:45056
    ds_read_b128 v[236:239], v1 offset:46080
    v_mfma_f32_32x32x16_bf16 v[200:215], v[244:247], v[8:11], v[200:215]
    s_lshl3_add_u32 m0, s74, s67
    s_add_u32 s75, s66, s74
    buffer_load_dwordx4 v5, s[52:55], s75 offen sc1 lds
    s_waitcnt lgkmcnt(2)
    v_mfma_f32_32x32x16_bf16 v[184:199], v[248:251], v[12:15], v[184:199]
    ds_read_b128 v[240:243], v1 offset:51200
    ds_read_b128 v[244:247], v1 offset:52224
    v_mfma_f32_32x32x16_bf16 v[200:215], v[252:255], v[12:15], v[200:215]
    s_waitcnt lgkmcnt(2)
    v_mfma_f32_32x32x16_bf16 v[184:199], v[232:235], v[16:19], v[184:199]
    ds_read_b128 v[248:251], v1 offset:36864
    ds_read_b128 v[252:255], v1 offset:37888
    v_mfma_f32_32x32x16_bf16 v[200:215], v[236:239], v[16:19], v[200:215]
    s_waitcnt lgkmcnt(2)
    v_mfma_f32_32x32x16_bf16 v[184:199], v[240:243], v[20:23], v[184:199]
    ds_read_b128 v[232:235], v1 offset:43008
    ds_read_b128 v[236:239], v1 offset:44032
    v_mfma_f32_32x32x16_bf16 v[200:215], v[244:247], v[20:23], v[200:215]
    s_waitcnt lgkmcnt(2)
    v_mfma_f32_32x32x16_bf16 v[8:23], v[248:251], v[96:99], 0
    ds_read_b128 v[240:243], v1 offset:45056
    ds_read_b128 v[244:247], v1 offset:46080
    v_mfma_f32_32x32x16_bf16 v[216:231], v[252:255], v[96:99], v[216:231]
    s_waitcnt lgkmcnt(2)
    v_mfma_f32_32x32x16_bf16 v[8:23], v[232:235], v[100:103], v[8:23]
    ds_read_b128 v[96:99], v1 offset:51200
    ds_read_b128 v[248:251], v1 offset:52224
    v_mfma_f32_32x32x16_bf16 v[216:231], v[236:239], v[100:103], v[216:231]
    s_waitcnt lgkmcnt(2)
    v_mfma_f32_32x32x16_bf16 v[8:23], v[240:243], v[104:107], v[8:23]
    ds_read_b128 v[252:255], v1 offset:53248
    ds_read_b128 v[100:103], v1 offset:54272
    v_mfma_f32_32x32x16_bf16 v[216:231], v[244:247], v[104:107], v[216:231]
    s_waitcnt lgkmcnt(2)
    v_mfma_f32_32x32x16_bf16 v[8:23], v[96:99], v[108:111], v[8:23]
    ds_read_b128 v[232:235], v1 offset:59392
    ds_read_b128 v[236:239], v1 offset:60416
    v_mfma_f32_32x32x16_bf16 v[216:231], v[248:251], v[108:111], v[216:231]
    s_waitcnt lgkmcnt(2)
    v_mfma_f32_32x32x16_bf16 v[184:199], v[252:255], v[24:27], v[184:199]
    ds_read_b128 v[104:107], v1 offset:61440
    v_mfma_f32_32x32x16_bf16 v[200:215], v[100:103], v[24:27], v[200:215]
    ds_read_b128 v[240:243], v1 offset:62464
    v_mfma_f32_32x32x16_bf16 v[8:23], v[252:255], v[112:115], v[8:23]
    v_mfma_f32_32x32x16_bf16 v[216:231], v[100:103], v[112:115], v[216:231]
    s_waitcnt lgkmcnt(2)
    v_mfma_f32_32x32x16_bf16 v[184:199], v[232:235], v[28:31], v[184:199]
    v_mov_b32 v0, 1
    s_mov_b64 exec, 1
    s_waitcnt vmcnt(0)
    ds_add_u32 v7, v0 offset:24
    s_mov_b64 exec, -1
    v_mfma_f32_32x32x16_bf16 v[200:215], v[236:239], v[28:31], v[200:215]
    v_mfma_f32_32x32x16_bf16 v[8:23], v[232:235], v[116:119], v[8:23]
    v_mfma_f32_32x32x16_bf16 v[216:231], v[236:239], v[116:119], v[216:231]
    ds_read_b32 v0, v7 offset:24
    s_waitcnt lgkmcnt(2)
    v_mfma_f32_32x32x16_bf16 v[184:199], v[104:107], v[32:35], v[184:199]
    s_waitcnt lgkmcnt(0)
    v_readfirstlane_b32 s71, v0
    s_cmp_ge_u32 s71, 4
    s_cbranch_scc1 L_cw2_x
    s_mov_b32 s70, 16000000
L_cw2:
    ds_read_b32 v0, v7 offset:24
    s_waitcnt lgkmcnt(0)
    v_readfirstlane_b32 s71, v0
    s_cmp_ge_u32 s71, 4
    s_cbranch_scc1 L_cw2_x
    s_sub_u32 s70, s70, 1
    s_cbranch_scc0 L_cw2
L_cw2_x:
    ds_read_b128 v[244:247], v1 offset:0
    ds_read_b128 v[108:111], v1 offset:1024
    ds_read_b128 v[96:99], v1 offset:2048
    ds_read_b128 v[248:251], v1 offset:3072
    v_mfma_f32_32x32x16_bf16 v[200:215], v[240:243], v[32:35], v[200:215]
    v_mfma_f32_32x32x16_bf16 v[8:23], v[104:107], v[120:123], v[8:23]
    v_mfma_f32_32x32x16_bf16 v[216:231], v[240:243], v[120:123], v[216:231]
    s_waitcnt lgkmcnt(2)
    v_mfma_f32_32x32x16_bf16 v[184:199], v[244:247], v[36:39], v[184:199]
    ds_read_b128 v[24:27], v1 offset:4096
    v_mfma_f32_32x32x16_bf16 v[200:215], v[108:111], v[36:39], v[200:215]
    ds_read_b128 v[112:115], v1 offset:5120
    v_mfma_f32_32x32x16_bf16 v[8:23], v[244:247], v[124:127], v[8:23]
    v_mfma_f32_32x32x16_bf16 v[216:231], v[108:111], v[124:127], v[216:231]
    s_waitcnt lgkmcnt(2)
    v_mfma_f32_32x32x16_bf16 v[184:199], v[96:99], v[40:43], v[184:199]
    ds_read_b128 v[252:255], v1 offset:6144
    v_mfma_f32_32x32x16_bf16 v[200:215], v[248:251], v[40:43], v[200:215]
    ds_read_b128 v[100:103], v1 offset:7168
    v_mfma_f32_32x32x16_bf16 v[8:23], v[96:99], v[128:131], v[8:23]
    v_mfma_f32_32x32x16_bf16 v[216:231], v[248:251], v[128:131], v[216:231]
    s_waitcnt lgkmcnt(2)
    v_mfma_f32_32x32x16_bf16 v[184:199], v[24:27], v[44:47], v[184:199]
    ds_read_b128 v[28:31], v1 offset:8192
    v_mfma_f32_32x32x16_bf16 v[200:215], v[112:115], v[44:47], v[200:215]
    ds_read_b128 v[116:119], v1 offset:9216
    v_mfma_f32_32x32x16_bf16 v[8:23], v[24:27], v[132:135], v[8:23]
    v_mfma_f32_32x32x16_bf16 v[216:231], v[112:115], v[132:135], v[216:231]
    s_waitcnt lgkmcnt(2)
    v_mfma_f32_32x32x16_bf16 v[184:199], v[252:255], v[48:51], v[184:199]
    ds_read_b128 v[232:235], v1 offset:10240
    v_mfma_f32_32x32x16_bf16 v[200:215], v[100:103], v[48:51], v[200:215]
    ds_read_b128 v[236:239], v1 offset:11264
    v_mfma_f32_32x32x16_bf16 v[8:23], v[252:255], v[136:139], v[8:23]
    v_mfma_f32_32x32x16_bf16 v[216:231], v[100:103], v[136:139], v[216:231]
    s_waitcnt lgkmcnt(2)
    v_mfma_f32_32x32x16_bf16 v[184:199], v[28:31], v[52:55], v[184:199]
    ds_read_b128 v[32:35], v1 offset:12288
    v_mfma_f32_32x32x16_bf16 v[200:215], v[116:119], v[52:55], v[200:215]
    ds_read_b128 v[120:123], v1 offset:13312
    v_mfma_f32_32x32x16_bf16 v[8:23], v[28:31], v[140:143], v[8:23]
    v_mfma_f32_32x32x16_bf16 v[216:231], v[116:119], v[140:143], v[216:231]
    s_waitcnt lgkmcnt(2)
    v_mfma_f32_32x32x16_bf16 v[184:199], v[232:235], v[56:59], v[184:199]
    ds_read_b128 v[104:107], v1 offset:14336
    v_mfma_f32_32x32x16_bf16 v[200:215], v[236:239], v[56:59], v[200:215]
    ds_read_b128 v[240:243], v1 offset:15360
    v_mfma_f32_32x32x16_bf16 v[8:23], v[232:235], v[144:147], v[8:23]
    v_mfma_f32_32x32x16_bf16 v[216:231], v[236:239], v[144:147], v[216:231]
    s_waitcnt lgkmcnt(2)
    v_mfma_f32_32x32x16_bf16 v[184:199], v[32:35], v[60:63], v[184:199]
    ds_read_b128 v[36:39], v1 offset:16384
    v_mfma_f32_32x32x16_bf16 v[200:215], v[120:123], v[60:63], v[200:215]
    ds_read_b128 v[124:127], v1 offset:17408
    v_mfma_f32_32x32x16_bf16 v[8:23], v[32:35], v[148:151], v[8:23]
    v_mfma_f32_32x32x16_bf16 v[216:231], v[120:123], v[148:151], v[216:231]
    s_waitcnt lgkmcnt(2)
    v_mfma_f32_32x32x16_bf16 v[184:199], v[104:107], v[64:67], v[184:199]
    ds_read_b128 v[244:247], v1 offset:18432
    v_mfma_f32_32x32x16_bf16 v[200:215], v[240:243], v[64:67], v[200:215]
    ds_read_b128 v[108:111], v1 offset:19456
    v_mfma_f32_32x32x16_bf16 v[8:23], v[104:107], v[152:155], v[8:23]
    v_mfma_f32_32x32x16_bf16 v[216:231], v[240:243], v[152:155], v[216:231]
    s_waitcnt lgkmcnt(2)
    v_mfma_f32_32x32x16_bf16 v[184:199], v[36:39], v[68:71], v[184:199]
    ds_read_b128 v[40:43], v1 offset:20480
    v_mfma_f32_32x32x16_bf16 v[200:215], v[124:127], v[68:71], v[200:215]
    ds_read_b128 v[128:131], v1 offset:21504
    v_mfma_f32_32x32x16_bf16 v[8:23], v[36:39], v[156:159], v[8:23]
    v_mfma_f32_32x32x16_bf16 v[216:231], v[124:127], v[156:159], v[216:231]
    s_waitcnt lgkmcnt(2)
    v_mfma_f32_32x32x16_bf16 v[184:199], v[244:247], v[72:75], v[184:199]
    ds_read_b128 v[96:99], v1 offset:22528
    v_mfma_f32_32x32x16_bf16 v[200:215], v[108:111], v[72:75], v[200:215]
    ds_read_b128 v[248:251], v1 offset:23552
    v_mfma_f32_32x32x16_bf16 v[8:23], v[244:247], v[160:163], v[8:23]
    v_mfma_f32_32x32x16_bf16 v[216:231], v[108:111], v[160:163], v[216:231]
    s_waitcnt lgkmcnt(2)
    v_mfma_f32_32x32x16_bf16 v[184:199], v[40:43], v[76:79], v[184:199]
    ds_read_b128 v[44:47], v1 offset:24576
    v_mfma_f32_32x32x16_bf16 v[200:215], v[128:131], v[76:79], v[200:215]
    ds_read_b128 v[132:135], v1 offset:25600
    v_mfma_f32_32x32x16_bf16 v[8:23], v[40:43], v[164:167], v[8:23]
    v_mfma_f32_32x32x16_bf16 v[216:231], v[128:131], v[164:167], v[216:231]
    s_waitcnt lgkmcnt(2)
    v_mfma_f32_32x32x16_bf16 v[184:199], v[96:99], v[80:83], v[184:199]
    ds_read_b128 v[24:27], v1 offset:26624
    v_mfma_f32_32x32x16_bf16 v[200:215], v[248:251], v[80:83], v[200:215]
    ds_read_b128 v[112:115], v1 offset:27648
    v_mfma_f32_32x32x16_bf16 v[8:23], v[96:99], v[168:171], v[8:23]
    v_mfma_f32_32x32x16_bf16 v[216:231], v[248:251], v[168:171], v[216:231]
    s_waitcnt lgkmcnt(2)
    v_mfma_f32_32x32x16_bf16 v[184:199], v[44:47], v[84:87], v[184:199]
    ds_read_b128 v[48:51], v1 offset:28672
    v_mfma_f32_32x32x16_bf16 v[200:215], v[132:135], v[84:87], v[200:215]
    ds_read_b128 v[136:139], v1 offset:29696
    v_mfma_f32_32x32x16_bf16 v[8:23], v[44:47], v[172:175], v[8:23]
    v_mfma_f32_32x32x16_bf16 v[216:231], v[132:135], v[172:175], v[216:231]
    buffer_load_dwordx2 v[252:253], v6, s[52:55], 0 offen sc1
    s_waitcnt lgkmcnt(2)
    v_mfma_f32_32x32x16_bf16 v[184:199], v[24:27], v[88:91], v[184:199]
    v_mfma_f32_32x32x16_bf16 v[200:215], v[112:115], v[88:91], v[200:215]
    v_mfma_f32_32x32x16_bf16 v[8:23], v[24:27], v[176:179], v[8:23]
    v_mfma_f32_32x32x16_bf16 v[216:231], v[112:115], v[176:179], v[216:231]
    s_waitcnt lgkmcnt(0)
    v_mfma_f32_32x32x16_bf16 v[184:199], v[48:51], v[92:95], v[184:199]
    v_mfma_f32_32x32x16_bf16 v[200:215], v[136:139], v[92:95], v[200:215]
    v_mfma_f32_32x32x16_bf16 v[8:23], v[48:51], v[180:183], v[8:23]
    v_mfma_f32_32x32x16_bf16 v[216:231], v[136:139], v[180:183], v[216:231]
    s_add_u32 s38, s38, 1
    s_xor_b32 s39, s39, s38
    s_and_b32 s39, s39, 0xff
    s_lshl_b32 s9, s9, 16
    s_lshl_b32 s72, s6, 1
    s_lshl_b32 s73, s6, 3
    s_add_u32 s73, s73, 327680
    v_mov_b32 v103, s38
    s_nop 1
    v_mul_f32 v100, v184, v200
    v_mul_f32 v101, v185, v201
    v_fmac_f32 v100, v186, v202
    v_fmac_f32 v101, v187, v203
    v_fmac_f32 v100, v188, v204
    v_fmac_f32 v101, v189, v205
    v_fmac_f32 v100, v190, v206
    v_fmac_f32 v101, v191, v207
    v_fmac_f32 v100, v192, v208
    v_fmac_f32 v101, v193, v209
    v_fmac_f32 v100, v194, v210
    v_fmac_f32 v101, v195, v211
    v_fmac_f32 v100, v196, v212
    v_fmac_f32 v101, v197, v213
    v_fmac_f32 v100, v8, v216
    v_fmac_f32 v101, v9, v217
    v_fmac_f32 v100, v10, v218
    v_fmac_f32 v101, v11, v219
    v_fmac_f32 v100, v12, v220
    v_fmac_f32 v101, v13, v221
    v_fmac_f32 v100, v14, v222
    v_fmac_f32 v101, v15, v223
    v_fmac_f32 v100, v16, v224
    v_fmac_f32 v101, v17, v225
    v_fmac_f32 v100, v18, v226
    v_fmac_f32 v101, v19, v227
    v_fmac_f32 v100, v20, v228
    v_fmac_f32 v101, v21, v229
    v_add_f32 v100, v100, v101
    s_mov_b32 exec_lo, 0x3ffffff
    s_mov_b32 exec_hi, 0
    s_mov_b32 s70, 2000000
L_poll2:
    buffer_load_dwordx2 v[254:255], v6, s[52:55], 0 offen sc1
    s_waitcnt vmcnt(1)
    v_and_b32 v101, 0xff, v253
    v_cmp_eq_u32 vcc, s38, v252
    v_cmp_eq_u32 s[66:67], s39, v101
    v_and_b32 v101, 0xffffff00, v253
    s_and_b64 vcc, vcc, s[66:67]
    s_cmp_eq_u64 vcc, exec
    s_cbranch_scc1 L_got
    buffer_load_dwordx2 v[252:253], v6, s[52:55], 0 offen sc1
    s_waitcnt vmcnt(1)
    v_and_b32 v101, 0xff, v255
    v_cmp_eq_u32 vcc, s38, v254
    v_cmp_eq_u32 s[66:67], s39, v101
    v_and_b32 v101, 0xffffff00, v255
    s_and_b64 vcc, vcc, s[66:67]
    s_cmp_eq_u64 vcc, exec
    s_cbranch_scc1 L_got
    s_sub_u32 s70, s70, 1
    s_cbranch_scc0 L_poll2
L_got:
    v_add_f32 v100, v100, v101
    s_mov_b64 exec, -1
    s_nop 1
    v_add_f32_dpp v100, v100, v100 quad_perm:[1,0,3,2] row_mask:0xf bank_mask:0xf
    s_nop 1
    v_add_f32_dpp v100, v100, v100 quad_perm:[2,3,0,1] row_mask:0xf bank_mask:0xf
    s_nop 1
    v_add_f32_dpp v100, v100, v100 row_half_mirror row_mask:0xf bank_mask:0xf
    s_nop 1
    v_add_f32_dpp v100, v100, v100 row_mirror row_mask:0xf bank_mask:0xf
    s_nop 1
    v_add_f32_dpp v100, v100, v100 row_bcast:15 row_mask:0xa bank_mask:0xf
    s_nop 1
    v_add_f32_dpp v100, v100, v100 row_bcast:31 row_mask:0xc bank_mask:0xf
    s_mov_b32 exec_lo, 0
    s_mov_b32 exec_hi, 0x80000000
    v_add_f32 v100, s9, v100
    v_cvt_pk_bf16_f32 v100, v100, v100
    buffer_store_short v100, off, s[60:63], s72
    buffer_store_dword v103, off, s[52:55], s73
    s_endpgm
L_fold_b:
    s_cmp_ge_u32 s3, 4
    s_cbranch_scc1 L_aux_w1
    v_and_b32 v8, 31, v2
    v_lshrrev_b32 v15, 5, v2
    v_mul_u32_u24 v10, 10816, v15
    v_lshl_add_u32 v10, v8, 1, v10
    v_cmp_gt_u32 vcc, 26, v8
    s_mul_i32 s69, s6, 52
    s_add_u32 s69, s69, 35152
    v_cndmask_b32 v10, v7, v10, vcc
    v_cmp_gt_u32 vcc, 32, v2
    v_lshlrev_b32 v12, 2, v2
    s_nop 0
    v_cndmask_b32 v11, v7, v10, vcc
    s_add_u32 s68, s69, 0
    buffer_load_ushort v76, v10, s[48:51], s68 offen offset:0
    buffer_load_ushort v77, v10, s[48:51], s68 offen offset:1352
    buffer_load_ushort v78, v10, s[48:51], s68 offen offset:2704
    s_add_u32 s68, s69, 4056
    buffer_load_ushort v79, v10, s[48:51], s68 offen offset:0
    buffer_load_ushort v80, v10, s[48:51], s68 offen offset:1352
    buffer_load_ushort v81, v10, s[48:51], s68 offen offset:2704
    s_add_u32 s68, s69, 8112
    buffer_load_ushort v82, v10, s[48:51], s68 offen offset:0
    buffer_load_ushort v83, v10, s[48:51], s68 offen offset:1352
    s_add_u32 s68, s69, 21632
    buffer_load_ushort v84, v10, s[48:51], s68 offen offset:0
    buffer_load_ushort v85, v10, s[48:51], s68 offen offset:1352
    s_add_u32 s68, s69, 24336
    buffer_load_ushort v86, v11, s[48:51], s68 offen offset:0
    buffer_load_ushort v87, v11, s[48:51], s68 offen offset:1352
    buffer_load_ushort v88, v11, s[48:51], s68 offen offset:2704
    s_add_u32 s68, s69, 28392
    buffer_load_ushort v89, v11, s[48:51], s68 offen offset:0
    buffer_load_ushort v90, v11, s[48:51], s68 offen offset:1352
    buffer_load_ushort v91, v11, s[48:51], s68 offen offset:2704
    s_mov_b32 s60, s22
    s_mov_b32 s61, s23
    s_mov_b32 s62, 156
    s_mov_b32 s63, 0x20000
    buffer_load_dword v13, v12, s[60:63], 0 offen offset:52
    s_lshl_b32 s68, s6, 1
    buffer_load_ushort v14, off, s[60:63], s68
    v_lshlrev_b32 v8, 6, v2
    v_mov_b32 v9, 0
    s_mov_b32 exec_lo, 0x7ffffff
    s_mov_b32 exec_hi, 0
    ds_write_b32 v8, v9 offset:52
    ds_write_b32 v8, v9 offset:56
    ds_write_b32 v8, v9 offset:60
    s_mov_b64 exec, -1
    v_and_b32 v8, 31, v2
    v_lshlrev_b32 v93, 6, v8
    v_lshl_add_u32 v93, v15, 4, v93
    s_mul_i32 s67, s3, 5120
    s_add_u32 s67, s67, 4096
    v_mul_u32_u24 v92, 144, v8
    v_lshl_add_u32 v92, v15, 4, v92
    v_add_u32 v92, s67, v92
    v_add_u32 v8, 0, v4
    v_mul_u32_u24 v9, 5042, v8
    v_lshrrev_b32 v9, 16, v9
    v_mul_u32_u24 v10, 13, v9
    v_sub_u32 v10, v8, v10
    v_lshl_add_u32 v44, v10, 1, v5
    v_add_u32 v52, v44, v9
    v_subrev_u32 v10, 26, v52
    v_min_u32 v52, v52, v10
    v_add_u32 v8, 1, v4
    v_mul_u32_u24 v9, 5042, v8
    v_lshrrev_b32 v9, 16, v9
    v_mul_u32_u24 v10, 13, v9
    v_sub_u32 v10, v8, v10
    v_lshl_add_u32 v45, v10, 1, v5
    v_add_u32 v53, v45, v9
    v_subrev_u32 v10, 26, v53
    v_min_u32 v53, v53, v10
    v_add_u32 v8, 2, v4
    v_mul_u32_u24 v9, 5042, v8
    v_lshrrev_b32 v9, 16, v9
    v_mul_u32_u24 v10, 13, v9
    v_sub_u32 v10, v8, v10
    v_lshl_add_u32 v46, v10, 1, v5
    v_add_u32 v54, v46, v9
    v_subrev_u32 v10, 26, v54
    v_min_u32 v54, v54, v10
    v_add_u32 v8, 3, v4
    v_mul_u32_u24 v9, 5042, v8
    v_lshrrev_b32 v9, 16, v9
    v_mul_u32_u24 v10, 13, v9
    v_sub_u32 v10, v8, v10
    v_lshl_add_u32 v47, v10, 1, v5
    v_add_u32 v55, v47, v9
    v_subrev_u32 v10, 26, v55
    v_min_u32 v55, v55, v10
    v_add_u32 v8, 4, v4
    v_mul_u32_u24 v9, 5042, v8
    v_lshrrev_b32 v9, 16, v9
    v_mul_u32_u24 v10, 13, v9
    v_sub_u32 v10, v8, v10
    v_lshl_add_u32 v48, v10, 1, v5
    v_add_u32 v56, v48, v9
    v_subrev_u32 v10, 26, v56
    v_min_u32 v56, v56, v10
    v_add_u32 v8, 5, v4
    v_mul_u32_u24 v9, 5042, v8
    v_lshrrev_b32 v9, 16, v9
    v_mul_u32_u24 v10, 13, v9
    v_sub_u32 v10, v8, v10
    v_lshl_add_u32 v49, v10, 1, v5
    v_add_u32 v57, v49, v9
    v_subrev_u32 v10, 26, v57
    v_min_u32 v57, v57, v10
    v_add_u32 v8, 6, v4
    v_mul_u32_u24 v9, 5042, v8
    v_lshrrev_b32 v9, 16, v9
    v_mul_u32_u24 v10, 13, v9
    v_sub_u32 v10, v8, v10
    v_lshl_add_u32 v50, v10, 1, v5
    v_add_u32 v58, v50, v9
    v_subrev_u32 v10, 26, v58
    v_min_u32 v58, v58, v10
    v_add_u32 v8, 7, v4
    v_mul_u32_u24 v9, 5042, v8
    v_lshrrev_b32 v9, 16, v9
    v_mul_u32_u24 v10, 13, v9
    v_sub_u32 v10, v8, v10
    v_lshl_add_u32 v51, v10, 1, v5
    v_add_u32 v59, v51, v9
    v_subrev_u32 v10, 26, v59
    v_min_u32 v59, v59, v10
    v_cmp_lt_u32 vcc, 43, v2
    v_subrev_u32 v10, 176, v4
    v_mov_b32 v11, 26
    v_add_u32 v8, 0, v10
    v_lshl_add_u32 v8, v8, 1, v5
    v_min_u32 v8, 31, v8
    v_cndmask_b32 v8, v52, v8, vcc
    v_cndmask_b32 v9, v44, v11, vcc
    v_mul_u32_u24 v9, 144, v9
    v_lshl_add_u32 v9, v8, 2, v9
    v_add_u32 v68, s67, v9
    v_add_u32 v8, 1, v10
    v_lshl_add_u32 v8, v8, 1, v5
    v_min_u32 v8, 31, v8
    v_cndmask_b32 v8, v53, v8, vcc
    v_cndmask_b32 v9, v45, v11, vcc
    v_mul_u32_u24 v9, 144, v9
    v_lshl_add_u32 v9, v8, 2, v9
    v_add_u32 v69, s67, v9
    v_add_u32 v8, 2, v10
    v_lshl_add_u32 v8, v8, 1, v5
    v_min_u32 v8, 31, v8
    v_cndmask_b32 v8, v54, v8, vcc
    v_cndmask_b32 v9, v46, v11, vcc
    v_mul_u32_u24 v9, 144, v9
    v_lshl_add_u32 v9, v8, 2, v9
    v_add_u32 v70, s67, v9
    v_add_u32 v8, 3, v10
    v_lshl_add_u32 v8, v8, 1, v5
    v_min_u32 v8, 31, v8
    v_cndmask_b32 v8, v55, v8, vcc
    v_cndmask_b32 v9, v47, v11, vcc
    v_mul_u32_u24 v9, 144, v9
    v_lshl_add_u32 v9, v8, 2, v9
    v_add_u32 v71, s67, v9
    v_add_u32 v8, 4, v10
    v_lshl_add_u32 v8, v8, 1, v5
    v_min_u32 v8, 31, v8
    v_cndmask_b32 v8, v56, v8, vcc
    v_cndmask_b32 v9, v48, v11, vcc
    v_mul_u32_u24 v9, 144, v9
    v_lshl_add_u32 v9, v8, 2, v9
    v_add_u32 v72, s67, v9
    v_add_u32 v8, 5, v10
    v_lshl_add_u32 v8, v8, 1, v5
    v_min_u32 v8, 31, v8
    v_cndmask_b32 v8, v57, v8, vcc
    v_cndmask_b32 v9, v49, v11, vcc
    v_mul_u32_u24 v9, 144, v9
    v_lshl_add_u32 v9, v8, 2, v9
    v_add_u32 v73, s67, v9
    v_add_u32 v8, 6, v10
    v_lshl_add_u32 v8, v8, 1, v5
    v_min_u32 v8, 31, v8
    v_cndmask_b32 v8, v58, v8, vcc
    v_cndmask_b32 v9, v50, v11, vcc
    v_mul_u32_u24 v9, 144, v9
    v_lshl_add_u32 v9, v8, 2, v9
    v_add_u32 v74, s67, v9
    v_add_u32 v8, 7, v10
    v_lshl_add_u32 v8, v8, 1, v5
    v_min_u32 v8, 31, v8
    v_cndmask_b32 v8, v59, v8, vcc
    v_cndmask_b32 v9, v51, v11, vcc
    v_mul_u32_u24 v9, 144, v9
    v_lshl_add_u32 v9, v8, 2, v9
    v_add_u32 v75, s67, v9
    v_lshrrev_b32 v8, 1, v2
    v_lshl_add_u32 v6, v8, 1, 1
    v_add_u32 v8, 22, v8
    v_cndmask_b32 v6, v6, v8, vcc
    v_lshlrev_b32 v6, 7, v6
    v_lshl_add_u32 v6, v5, 6, v6
    s_and_b32 s67, s3, 3
    s_lshl_b32 s67, s67, 4
    s_add_u32 s67, s67, 49152
    v_add_u32 v6, s67, v6
    v_cmp_gt_u32 vcc, 48, v2
    v_mov_b32 v94, 1.0
    v_mov_b32 v8, 57344
    v_cndmask_b32 v6, v8, v6, vcc
    v_cmp_gt_u32 vcc, 2, v2
    s_nop 1
    v_cndmask_b32 v95, v94, 0.5, vcc
    v_cmp_gt_u32 vcc, 4, v2
    s_nop 1
    v_cndmask_b32 v94, v94, 0.5, vcc
    v_mul_u32_u24 v8, 5042, v0
    v_lshrrev_b32 v8, 16, v8
    v_mul_u32_u24 v9, 13, v8
    v_sub_u32 v9, v0, v9
    v_lshlrev_b32 v9, 7, v9
    v_lshl_add_u32 v96, v8, 1, v9
    s_waitcnt lgkmcnt(0)
    s_lshl_b32 s70, s76, 16
    s_waitcnt vmcnt(40)
    v_lshlrev_b32 v8, 16, v16
    v_and_b32 v9, 0xffff0000, v16
    v_mul_f32 v10, s70, v8
    v_mul_f32 v11, s70, v9
    s_and_b32 s71, s76, 0xffff0000
    v_lshlrev_b32 v8, 16, v17
    v_and_b32 v9, 0xffff0000, v17
    v_fmac_f32 v10, s71, v8
    v_fmac_f32 v11, s71, v9
    s_lshl_b32 s70, s77, 16
    v_lshlrev_b32 v8, 16, v18
    v_and_b32 v9, 0xffff0000, v18
    v_fmac_f32 v10, s70, v8
    v_fmac_f32 v11, s70, v9
    s_and_b32 s71, s77, 0xffff0000
    v_lshlrev_b32 v8, 16, v19
    v_and_b32 v9, 0xffff0000, v19
    v_fmac_f32 v10, s71, v8
    v_fmac_f32 v11, s71, v9
    s_lshl_b32 s70, s78, 16
    s_waitcnt vmcnt(36)
    v_lshlrev_b32 v8, 16, v20
    v_and_b32 v9, 0xffff0000, v20
    v_fmac_f32 v10, s70, v8
    v_fmac_f32 v11, s70, v9
    s_and_b32 s71, s78, 0xffff0000
    v_lshlrev_b32 v8, 16, v21
    v_and_b32 v9, 0xffff0000, v21
    v_fmac_f32 v10, s71, v8
    v_fmac_f32 v11, s71, v9
    s_lshl_b32 s70, s79, 16
    v_lshlrev_b32 v8, 16, v22
    v_and_b32 v9, 0xffff0000, v22
    v_fmac_f32 v10, s70, v8
    v_fmac_f32 v11, s70, v9
    s_and_b32 s71, s79, 0xffff0000
    v_lshlrev_b32 v8, 16, v23
    v_and_b32 v9, 0xffff0000, v23
    v_fmac_f32 v10, s71, v8
    v_fmac_f32 v11, s71, v9
    s_lshl_b32 s70, s80, 16
    s_waitcnt vmcnt(32)
    v_lshlrev_b32 v8, 16, v24
    v_and_b32 v9, 0xffff0000, v24
    v_fmac_f32 v10, s70, v8
    v_fmac_f32 v11, s70, v9
    s_and_b32 s71, s80, 0xffff0000
    v_lshlrev_b32 v8, 16, v25
    v_and_b32 v9, 0xffff0000, v25
    v_fmac_f32 v10, s71, v8
    v_fmac_f32 v11, s71, v9
    s_lshl_b32 s70, s81, 16
    v_lshlrev_b32 v8, 16, v26
    v_and_b32 v9, 0xffff0000, v26
    v_fmac_f32 v10, s70, v8
    v_fmac_f32 v11, s70, v9
    s_and_b32 s71, s81, 0xffff0000
    v_lshlrev_b32 v8, 16, v27
    v_and_b32 v9, 0xffff0000, v27
    v_fmac_f32 v10, s71, v8
    v_fmac_f32 v11, s71, v9
    s_lshl_b32 s70, s82, 16
    s_waitcnt vmcnt(28)
    v_lshlrev_b32 v8, 16, v28
    v_and_b32 v9, 0xffff0000, v28
    v_fmac_f32 v10, s70, v8
    v_fmac_f32 v11, s70, v9
    s_and_b32 s71, s82, 0xffff0000
    v_lshlrev_b32 v8, 16, v29
    v_and_b32 v9, 0xffff0000, v29
    v_fmac_f32 v10, s71, v8
    v_fmac_f32 v11, s71, v9
    s_lshl_b32 s70, s83, 16
    v_lshlrev_b32 v8, 16, v30
    v_and_b32 v9, 0xffff0000, v30
    v_fmac_f32 v10, s70, v8
    v_fmac_f32 v11, s70, v9
    s_and_b32 s71, s83, 0xffff0000
    v_lshlrev_b32 v8, 16, v31
    v_and_b32 v9, 0xffff0000, v31
    v_fmac_f32 v10, s71, v8
    v_fmac_f32 v11, s71, v9
    s_lshl_b32 s70, s84, 16
    s_waitcnt vmcnt(24)
    v_lshlrev_b32 v8, 16, v32
    v_and_b32 v9, 0xffff0000, v32
    v_fmac_f32 v10, s70, v8
    v_fmac_f32 v11, s70, v9
    s_and_b32 s71, s84, 0xffff0000
    v_lshlrev_b32 v8, 16, v33
    v_and_b32 v9, 0xffff0000, v33
    v_fmac_f32 v10, s71, v8
    v_fmac_f32 v11, s71, v9
    s_lshl_b32 s70, s85, 16
    v_lshlrev_b32 v8, 16, v34
    v_and_b32 v9, 0xffff0000, v34
    v_fmac_f32 v10, s70, v8
    v_fmac_f32 v11, s70, v9
    s_and_b32 s71, s85, 0xffff0000
    v_lshlrev_b32 v8, 16, v35
    v_and_b32 v9, 0xffff0000, v35
    v_fmac_f32 v10, s71, v8
    v_fmac_f32 v11, s71, v9
    s_lshl_b32 s70, s86, 16
    s_waitcnt vmcnt(20)
    v_lshlrev_b32 v8, 16, v36
    v_and_b32 v9, 0xffff0000, v36
    v_fmac_f32 v10, s70, v8
    v_fmac_f32 v11, s70, v9
    s_and_b32 s71, s86, 0xffff0000
    v_lshlrev_b32 v8, 16, v37
    v_and_b32 v9, 0xffff0000, v37
    v_fmac_f32 v10, s71, v8
    v_fmac_f32 v11, s71, v9
    s_lshl_b32 s70, s87, 16
    v_lshlrev_b32 v8, 16, v38
    v_and_b32 v9, 0xffff0000, v38
    v_fmac_f32 v10, s70, v8
    v_fmac_f32 v11, s70, v9
    s_and_b32 s71, s87, 0xffff0000
    v_lshlrev_b32 v8, 16, v39
    v_and_b32 v9, 0xffff0000, v39
    v_fmac_f32 v10, s71, v8
    v_fmac_f32 v11, s71, v9
    s_lshl_b32 s70, s88, 16
    s_waitcnt vmcnt(18)
    v_lshlrev_b32 v8, 16, v40
    v_and_b32 v9, 0xffff0000, v40
    v_fmac_f32 v10, s70, v8
    v_fmac_f32 v11, s70, v9
    s_and_b32 s71, s88, 0xffff0000
    v_lshlrev_b32 v8, 16, v41
    v_and_b32 v9, 0xffff0000, v41
    v_fmac_f32 v10, s71, v8
    v_fmac_f32 v11, s71, v9
    v_cvt_pk_bf16_f32 v10, v10, v11
    s_movk_i32 s67, 338
    v_cmp_gt_u32 vcc, s67, v0
    s_and_saveexec_b64 s[68:69], vcc
    ds_write_b16 v96, v10
    ds_write_b16_d16_hi v96, v10 offset:64
    s_mov_b64 exec, -1
    s_mov_b32 exec_lo, 0x1fff
    s_mov_b32 exec_hi, 0
    s_waitcnt vmcnt(0)
    ds_write_b32 v12, v13 offset:1664
    s_mov_b64 exec, -1
    v_lshl_or_b32 v60, v77, 16, v76
    v_lshl_or_b32 v61, v79, 16, v78
    v_lshl_or_b32 v62, v81, 16, v80
    v_lshl_or_b32 v63, v83, 16, v82
    v_lshl_or_b32 v64, v85, 16, v84
    v_lshl_or_b32 v65, v87, 16, v86
    v_lshl_or_b32 v66, v89, 16, v88
    v_lshl_or_b32 v67, v91, 16, v90
    s_waitcnt lgkmcnt(0)
    s_barrier
    ds_read_b128 v[16:19], v93
    ds_read_b128 v[20:23], v93 offset:32
    s_waitcnt lgkmcnt(0)
    v_mfma_f32_32x32x16_bf16 v[24:39], v[60:63], v[16:19], 0
    v_mfma_f32_32x32x16_bf16 v[24:39], v[64:67], v[20:23], v[24:39]
    v_mfma_f32_32x32x16_bf16 v[24:39], v[16:19], v[60:63], v[24:39]
    v_mfma_f32_32x32x16_bf16 v[24:39], v[20:23], v[64:67], v[24:39]
    s_nop 11
    ds_write_b128 v92, v[24:27] offset:0
    ds_write_b128 v92, v[28:31] offset:32
    ds_write_b128 v92, v[32:35] offset:64
    ds_write_b128 v92, v[36:39] offset:96
    s_waitcnt lgkmcnt(0)
    ds_read_b32 v16, v68
    ds_read_b32 v17, v69
    ds_read_b32 v18, v70
    ds_read_b32 v19, v71
    ds_read_b32 v20, v72
    ds_read_b32 v21, v73
    ds_read_b32 v22, v74
    ds_read_b32 v23, v75
    v_lshlrev_b32 v14, 16, v14
    v_cmp_eq_u32 s[66:67], 46, v2
    v_cmp_eq_u32 s[68:69], 47, v2
    v_cmp_lt_u32 vcc, 45, v2
    s_waitcnt lgkmcnt(0)
    v_cndmask_b32 v21, v21, v14, s[66:67]
    v_cndmask_b32 v21, v21, 0, s[68:69]
    v_cndmask_b32 v22, v22, 0, vcc
    v_cndmask_b32 v23, v23, 0, vcc
    s_branch L_aux_pack
L_aux_w1:
    s_mul_i32 s69, s6, 1352
    s_lshl_b32 s72, s3, 11
    s_add_u32 s72, s72, 24576
    s_mov_b32 m0, s72
    v_lshlrev_b32 v12, 4, v2
    buffer_load_dwordx4 v12, s[48:51], s69 offen lds
    buffer_load_dwordx4 v12, s[48:51], s69 offen offset:1024 lds
    v_add_u32 v8, 0, v4
    v_mul_u32_u24 v9, 5042, v8
    v_lshrrev_b32 v9, 16, v9
    v_mul_u32_u24 v10, 13, v9
    v_sub_u32 v10, v8, v10
    v_lshl_add_u32 v44, v10, 1, v5
    v_add_u32 v52, v44, v9
    v_subrev_u32 v10, 26, v52
    v_min_u32 v52, v52, v10
    v_add_u32 v8, 1, v4
    v_mul_u32_u24 v9, 5042, v8
    v_lshrrev_b32 v9, 16, v9
    v_mul_u32_u24 v10, 13, v9
    v_sub_u32 v10, v8, v10
    v_lshl_add_u32 v45, v10, 1, v5
    v_add_u32 v53, v45, v9
    v_subrev_u32 v10, 26, v53
    v_min_u32 v53, v53, v10
    v_add_u32 v8, 2, v4
    v_mul_u32_u24 v9, 5042, v8
    v_lshrrev_b32 v9, 16, v9
    v_mul_u32_u24 v10, 13, v9
    v_sub_u32 v10, v8, v10
    v_lshl_add_u32 v46, v10, 1, v5
    v_add_u32 v54, v46, v9
    v_subrev_u32 v10, 26, v54
    v_min_u32 v54, v54, v10
    v_add_u32 v8, 3, v4
    v_mul_u32_u24 v9, 5042, v8
    v_lshrrev_b32 v9, 16, v9
    v_mul_u32_u24 v10, 13, v9
    v_sub_u32 v10, v8, v10
    v_lshl_add_u32 v47, v10, 1, v5
    v_add_u32 v55, v47, v9
    v_subrev_u32 v10, 26, v55
    v_min_u32 v55, v55, v10
    v_add_u32 v8, 4, v4
    v_mul_u32_u24 v9, 5042, v8
    v_lshrrev_b32 v9, 16, v9
    v_mul_u32_u24 v10, 13, v9
    v_sub_u32 v10, v8, v10
    v_lshl_add_u32 v48, v10, 1, v5
    v_add_u32 v56, v48, v9
    v_subrev_u32 v10, 26, v56
    v_min_u32 v56, v56, v10
    v_add_u32 v8, 5, v4
    v_mul_u32_u24 v9, 5042, v8
    v_lshrrev_b32 v9, 16, v9
    v_mul_u32_u24 v10, 13, v9
    v_sub_u32 v10, v8, v10
    v_lshl_add_u32 v49, v10, 1, v5
    v_add_u32 v57, v49, v9
    v_subrev_u32 v10, 26, v57
    v_min_u32 v57, v57, v10
    v_add_u32 v8, 6, v4
    v_mul_u32_u24 v9, 5042, v8
    v_lshrrev_b32 v9, 16, v9
    v_mul_u32_u24 v10, 13, v9
    v_sub_u32 v10, v8, v10
    v_lshl_add_u32 v50, v10, 1, v5
    v_add_u32 v58, v50, v9
    v_subrev_u32 v10, 26, v58
    v_min_u32 v58, v58, v10
    v_add_u32 v8, 7, v4
    v_mul_u32_u24 v9, 5042, v8
    v_lshrrev_b32 v9, 16, v9
    v_mul_u32_u24 v10, 13, v9
    v_sub_u32 v10, v8, v10
    v_lshl_add_u32 v51, v10, 1, v5
    v_add_u32 v59, v51, v9
    v_subrev_u32 v10, 26, v59
    v_min_u32 v59, v59, v10
    v_mul_u32_u24 v8, 26, v44
    v_add_lshl_u32 v8, v8, v52, 1
    v_add_u32 v60, s72, v8
    v_mul_u32_u24 v9, 26, v52
    v_add_lshl_u32 v9, v9, v44, 1
    v_add_u32 v68, s72, v9
    v_mul_u32_u24 v8, 26, v45
    v_add_lshl_u32 v8, v8, v53, 1
    v_add_u32 v61, s72, v8
    v_mul_u32_u24 v9, 26, v53
    v_add_lshl_u32 v9, v9, v45, 1
    v_add_u32 v69, s72, v9
    v_mul_u32_u24 v8, 26, v46
    v_add_lshl_u32 v8, v8, v54, 1
    v_add_u32 v62, s72, v8
    v_mul_u32_u24 v9, 26, v54
    v_add_lshl_u32 v9, v9, v46, 1
    v_add_u32 v70, s72, v9
    v_mul_u32_u24 v8, 26, v47
    v_add_lshl_u32 v8, v8, v55, 1
    v_add_u32 v63, s72, v8
    v_mul_u32_u24 v9, 26, v55
    v_add_lshl_u32 v9, v9, v47, 1
    v_add_u32 v71, s72, v9
    v_mul_u32_u24 v8, 26, v48
    v_add_lshl_u32 v8, v8, v56, 1
    v_add_u32 v64, s72, v8
    v_mul_u32_u24 v9, 26, v56
    v_add_lshl_u32 v9, v9, v48, 1
    v_add_u32 v72, s72, v9
    v_mul_u32_u24 v8, 26, v49
    v_add_lshl_u32 v8, v8, v57, 1
    v_add_u32 v65, s72, v8
    v_mul_u32_u24 v9, 26, v57
    v_add_lshl_u32 v9, v9, v49, 1
    v_add_u32 v73, s72, v9
    v_mul_u32_u24 v8, 26, v50
    v_add_lshl_u32 v8, v8, v58, 1
    v_add_u32 v66, s72, v8
    v_mul_u32_u24 v9, 26, v58
    v_add_lshl_u32 v9, v9, v50, 1
    v_add_u32 v74, s72, v9
    v_mul_u32_u24 v8, 26, v51
    v_add_lshl_u32 v8, v8, v59, 1
    v_add_u32 v67, s72, v8
    v_mul_u32_u24 v9, 26, v59
    v_add_lshl_u32 v9, v9, v51, 1
    v_add_u32 v75, s72, v9
    v_and_b32 v6, 62, v2
    v_lshlrev_b32 v6, 7, v6
    v_lshl_add_u32 v6, v5, 6, v6
    s_and_b32 s67, s3, 3
    s_lshl_b32 s67, s67, 4
    s_add_u32 s67, s67, 49152
    v_add_u32 v6, s67, v6
    v_cmp_gt_u32 vcc, 44, v2
    v_mov_b32 v94, 1.0
    v_mov_b32 v8, 57344
    v_cndmask_b32 v6, v8, v6, vcc
    v_cmp_gt_u32 vcc, 2, v2
    s_nop 1
    v_cndmask_b32 v95, v94, 0.5, vcc
    v_cmp_gt_u32 vcc, 4, v2
    s_nop 1
    v_cndmask_b32 v94, v94, 0.5, vcc
    v_mul_u32_u24 v8, 5042, v0
    v_lshrrev_b32 v8, 16, v8
    v_mul_u32_u24 v9, 13, v8
    v_sub_u32 v9, v0, v9
    v_lshlrev_b32 v9, 7, v9
    v_lshl_add_u32 v96, v8, 1, v9
    s_waitcnt lgkmcnt(0)
    s_lshl_b32 s70, s76, 16
    s_waitcnt vmcnt(24)
    v_lshlrev_b32 v8, 16, v16
    v_and_b32 v9, 0xffff0000, v16
    v_mul_f32 v10, s70, v8
    v_mul_f32 v11, s70, v9
    s_and_b32 s71, s76, 0xffff0000
    v_lshlrev_b32 v8, 16, v17
    v_and_b32 v9, 0xffff0000, v17
    v_fmac_f32 v10, s71, v8
    v_fmac_f32 v11, s71, v9
    s_lshl_b32 s70, s77, 16
    v_lshlrev_b32 v8, 16, v18
    v_and_b32 v9, 0xffff0000, v18
    v_fmac_f32 v10, s70, v8
    v_fmac_f32 v11, s70, v9
    s_and_b32 s71, s77, 0xffff0000
    v_lshlrev_b32 v8, 16, v19
    v_and_b32 v9, 0xffff0000, v19
    v_fmac_f32 v10, s71, v8
    v_fmac_f32 v11, s71, v9
    s_lshl_b32 s70, s78, 16
    s_waitcnt vmcnt(20)
    v_lshlrev_b32 v8, 16, v20
    v_and_b32 v9, 0xffff0000, v20
    v_fmac_f32 v10, s70, v8
    v_fmac_f32 v11, s70, v9
    s_and_b32 s71, s78, 0xffff0000
    v_lshlrev_b32 v8, 16, v21
    v_and_b32 v9, 0xffff0000, v21
    v_fmac_f32 v10, s71, v8
    v_fmac_f32 v11, s71, v9
    s_lshl_b32 s70, s79, 16
    v_lshlrev_b32 v8, 16, v22
    v_and_b32 v9, 0xffff0000, v22
    v_fmac_f32 v10, s70, v8
    v_fmac_f32 v11, s70, v9
    s_and_b32 s71, s79, 0xffff0000
    v_lshlrev_b32 v8, 16, v23
    v_and_b32 v9, 0xffff0000, v23
    v_fmac_f32 v10, s71, v8
    v_fmac_f32 v11, s71, v9
    s_lshl_b32 s70, s80, 16
    s_waitcnt vmcnt(16)
    v_lshlrev_b32 v8, 16, v24
    v_and_b32 v9, 0xffff0000, v24
    v_fmac_f32 v10, s70, v8
    v_fmac_f32 v11, s70, v9
    s_and_b32 s71, s80, 0xffff0000
    v_lshlrev_b32 v8, 16, v25
    v_and_b32 v9, 0xffff0000, v25
    v_fmac_f32 v10, s71, v8
    v_fmac_f32 v11, s71, v9
    s_lshl_b32 s70, s81, 16
    v_lshlrev_b32 v8, 16, v26
    v_and_b32 v9, 0xffff0000, v26
    v_fmac_f32 v10, s70, v8
    v_fmac_f32 v11, s70, v9
    s_and_b32 s71, s81, 0xffff0000
    v_lshlrev_b32 v8, 16, v27
    v_and_b32 v9, 0xffff0000, v27
    v_fmac_f32 v10, s71, v8
    v_fmac_f32 v11, s71, v9
    s_lshl_b32 s70, s82, 16
    s_waitcnt vmcnt(12)
    v_lshlrev_b32 v8, 16, v28
    v_and_b32 v9, 0xffff0000, v28
    v_fmac_f32 v10, s70, v8
    v_fmac_f32 v11, s70, v9
    s_and_b32 s71, s82, 0xffff0000
    v_lshlrev_b32 v8, 16, v29
    v_and_b32 v9, 0xffff0000, v29
    v_fmac_f32 v10, s71, v8
    v_fmac_f32 v11, s71, v9
    s_lshl_b32 s70, s83, 16
    v_lshlrev_b32 v8, 16, v30
    v_and_b32 v9, 0xffff0000, v30
    v_fmac_f32 v10, s70, v8
    v_fmac_f32 v11, s70, v9
    s_and_b32 s71, s83, 0xffff0000
    v_lshlrev_b32 v8, 16, v31
    v_and_b32 v9, 0xffff0000, v31
    v_fmac_f32 v10, s71, v8
    v_fmac_f32 v11, s71, v9
    s_lshl_b32 s70, s84, 16
    s_waitcnt vmcnt(8)
    v_lshlrev_b32 v8, 16, v32
    v_and_b32 v9, 0xffff0000, v32
    v_fmac_f32 v10, s70, v8
    v_fmac_f32 v11, s70, v9
    s_and_b32 s71, s84, 0xffff0000
    v_lshlrev_b32 v8, 16, v33
    v_and_b32 v9, 0xffff0000, v33
    v_fmac_f32 v10, s71, v8
    v_fmac_f32 v11, s71, v9
    s_lshl_b32 s70, s85, 16
    v_lshlrev_b32 v8, 16, v34
    v_and_b32 v9, 0xffff0000, v34
    v_fmac_f32 v10, s70, v8
    v_fmac_f32 v11, s70, v9
    s_and_b32 s71, s85, 0xffff0000
    v_lshlrev_b32 v8, 16, v35
    v_and_b32 v9, 0xffff0000, v35
    v_fmac_f32 v10, s71, v8
    v_fmac_f32 v11, s71, v9
    s_lshl_b32 s70, s86, 16
    s_waitcnt vmcnt(4)
    v_lshlrev_b32 v8, 16, v36
    v_and_b32 v9, 0xffff0000, v36
    v_fmac_f32 v10, s70, v8
    v_fmac_f32 v11, s70, v9
    s_and_b32 s71, s86, 0xffff0000
    v_lshlrev_b32 v8, 16, v37
    v_and_b32 v9, 0xffff0000, v37
    v_fmac_f32 v10, s71, v8
    v_fmac_f32 v11, s71, v9
    s_lshl_b32 s70, s87, 16
    v_lshlrev_b32 v8, 16, v38
    v_and_b32 v9, 0xffff0000, v38
    v_fmac_f32 v10, s70, v8
    v_fmac_f32 v11, s70, v9
    s_and_b32 s71, s87, 0xffff0000
    v_lshlrev_b32 v8, 16, v39
    v_and_b32 v9, 0xffff0000, v39
    v_fmac_f32 v10, s71, v8
    v_fmac_f32 v11, s71, v9
    s_lshl_b32 s70, s88, 16
    s_waitcnt vmcnt(2)
    v_lshlrev_b32 v8, 16, v40
    v_and_b32 v9, 0xffff0000, v40
    v_fmac_f32 v10, s70, v8
    v_fmac_f32 v11, s70, v9
    s_and_b32 s71, s88, 0xffff0000
    v_lshlrev_b32 v8, 16, v41
    v_and_b32 v9, 0xffff0000, v41
    v_fmac_f32 v10, s71, v8
    v_fmac_f32 v11, s71, v9
    v_cvt_pk_bf16_f32 v10, v10, v11
    s_movk_i32 s67, 338
    v_cmp_gt_u32 vcc, s67, v0
    s_and_saveexec_b64 s[68:69], vcc
    ds_write_b16 v96, v10
    ds_write_b16_d16_hi v96, v10 offset:64
    s_mov_b64 exec, -1
    s_waitcnt lgkmcnt(0)
    s_barrier
    s_waitcnt vmcnt(0)
    ds_read_u16 v60, v60
    ds_read_u16 v68, v68
    ds_read_u16 v61, v61
    ds_read_u16 v69, v69
    ds_read_u16 v62, v62
    ds_read_u16 v70, v70
    ds_read_u16 v63, v63
    ds_read_u16 v71, v71
    ds_read_u16 v64, v64
    ds_read_u16 v72, v72
    ds_read_u16 v65, v65
    ds_read_u16 v73, v73
    ds_read_u16 v66, v66
    ds_read_u16 v74, v74
    ds_read_u16 v67, v67
    ds_read_u16 v75, v75
    s_waitcnt lgkmcnt(0)
    v_lshlrev_b32 v60, 16, v60
    v_lshlrev_b32 v68, 16, v68
    v_add_f32 v16, v60, v68
    v_lshlrev_b32 v61, 16, v61
    v_lshlrev_b32 v69, 16, v69
    v_add_f32 v17, v61, v69
    v_lshlrev_b32 v62, 16, v62
    v_lshlrev_b32 v70, 16, v70
    v_add_f32 v18, v62, v70
    v_lshlrev_b32 v63, 16, v63
    v_lshlrev_b32 v71, 16, v71
    v_add_f32 v19, v63, v71
    v_lshlrev_b32 v64, 16, v64
    v_lshlrev_b32 v72, 16, v72
    v_add_f32 v20, v64, v72
    v_lshlrev_b32 v65, 16, v65
    v_lshlrev_b32 v73, 16, v73
    v_add_f32 v21, v65, v73
    v_lshlrev_b32 v66, 16, v66
    v_lshlrev_b32 v74, 16, v74
    v_add_f32 v22, v66, v74
    v_lshlrev_b32 v67, 16, v67
    v_lshlrev_b32 v75, 16, v75
    v_add_f32 v23, v67, v75
L_aux_pack:
    s_mov_b32 s52, s36
    s_mov_b32 s53, s37
    s_mov_b32 s54, 2097152
    s_mov_b32 s55, 0x20000
    s_mov_b32 s56, s34
    s_mov_b32 s57, s35
    s_mov_b32 s58, 256
    s_mov_b32 s59, 0x20000
    v_cmp_eq_u32 vcc, 43, v2
    v_mul_f32 v16, v16, v94
    v_mul_f32 v17, v17, v94
    v_mul_f32 v18, v18, v94
    v_mul_f32 v19, v19, v94
    v_mul_f32 v20, v20, v94
    v_mul_f32 v21, v21, v95
    v_mul_f32 v22, v22, v95
    v_mul_f32 v23, v23, v95
    v_cndmask_b32 v23, v23, 0, vcc
    v_cvt_pk_bf16_f32 v24, v16, v17
    v_cvt_pk_bf16_f32 v25, v18, v19
    v_cvt_pk_bf16_f32 v26, v20, v21
    v_cvt_pk_bf16_f32 v27, v22, v23
    ds_write_b128 v6, v[24:27]
    v_lshlrev_b32 v8, 4, v0
    s_movk_i32 s67, 368
    v_cmp_gt_u32 vcc, s67, v0
    s_lshr_b32 s66, s6, 2
    s_mul_i32 s68, s66, 5888
    v_cndmask_b32 v9, v7, v8, vcc
    s_waitcnt lgkmcnt(0)
    s_barrier
    ds_read_b128 v[24:27], v8 offset:49152
    s_waitcnt lgkmcnt(0)
    buffer_store_dwordx4 v[24:27], v9, s[52:55], s68 offen sc0 sc1
    s_lshl_b32 s66, s66, 2
    v_mov_b32 v8, 1
    s_waitcnt vmcnt(0)
    s_barrier
    s_cmp_lg_u32 s3, 0
    s_cbranch_scc1 L_noflag
    s_mov_b64 exec, 1
    buffer_store_dword v8, off, s[56:59], s66 sc0 sc1
    s_mov_b64 exec, -1
L_noflag:
    s_branch L_aux_done
L_aux_done:
    s_cmp_lt_u32 s3, 4
    s_cbranch_scc1 L_end
    s_mov_b32 s44, s18
    s_mov_b32 s45, s19
    s_mov_b32 s46, 128000
    s_mov_b32 s47, 0x20000
    s_mov_b32 s40, s16
    s_mov_b32 s41, s17
    s_mov_b32 s42, 106496
    s_mov_b32 s43, 0x20000
    s_sub_u32 s72, s3, 4
    s_lshl2_add_u32 s6, s5, s72
    s_lshl_b32 s72, s4, 7
    s_add_u32 s6, s6, s72
    s_mul_i32 s72, s6, 104
    v_lshlrev_b32 v30, 2, v2
    buffer_load_dword v29, v30, s[40:43], s72 offen
    s_waitcnt vmcnt(0)
    v_mov_b32 v7, 160768
    v_mov_b32 v8, 4
    v_mov_b32 v9, 0
    ds_write_b32 v7, v8 offset:4
    ds_write_b32 v7, v8 offset:8
    ds_write_b32 v7, v8 offset:16
    ds_write_b32 v7, v9 offset:20
    ds_write_b32 v7, v9 offset:24
    s_waitcnt vmcnt(0)
    v_lshlrev_b32 v29, 7, v29
    v_and_b32 v3, 31, v2
    v_lshlrev_b32 v4, 2, v3
    v_readlane_b32 s76, v29, 0
    v_readlane_b32 s77, v29, 1
    v_readlane_b32 s78, v29, 2
    v_readlane_b32 s79, v29, 3
    v_readlane_b32 s80, v29, 4
    v_readlane_b32 s81, v29, 5
    v_readlane_b32 s82, v29, 6
    v_readlane_b32 s83, v29, 7
    v_readlane_b32 s84, v29, 8
    v_readlane_b32 s85, v29, 9
    v_readlane_b32 s86, v29, 10
    v_readlane_b32 s87, v29, 11
    v_readlane_b32 s88, v29, 12
    v_readlane_b32 s89, v29, 13
    v_readlane_b32 s90, v29, 14
    v_readlane_b32 s91, v29, 15
    v_readlane_b32 s92, v29, 16
    v_readlane_b32 s93, v29, 17
    v_readlane_b32 s94, v29, 18
    v_readlane_b32 s95, v29, 19
    v_readlane_b32 s96, v29, 20
    v_readlane_b32 s97, v29, 21
    v_readlane_b32 s98, v29, 22
    v_readlane_b32 s99, v29, 23
    v_readlane_b32 s100, v29, 24
    v_readlane_b32 s101, v29, 25
    s_mov_b32 exec_hi, 0
    v_xor_b32 v32, s76, v4
    v_xor_b32 v33, s77, v4
    v_xor_b32 v34, s78, v4
    v_xor_b32 v35, s79, v4
    v_xor_b32 v36, s80, v4
    v_xor_b32 v37, s81, v4
    v_xor_b32 v38, s82, v4
    v_xor_b32 v39, s83, v4
    v_xor_b32 v40, s84, v4
    v_xor_b32 v41, s85, v4
    v_xor_b32 v42, s86, v4
    v_xor_b32 v43, s87, v4
    v_xor_b32 v44, s88, v4
    v_xor_b32 v45, s89, v4
    v_xor_b32 v46, s90, v4
    v_xor_b32 v47, s91, v4
    v_xor_b32 v48, s92, v4
    v_xor_b32 v49, s93, v4
    v_xor_b32 v50, s94, v4
    v_xor_b32 v51, s95, v4
    v_xor_b32 v52, s96, v4
    v_xor_b32 v53, s97, v4
    v_xor_b32 v54, s98, v4
    v_xor_b32 v55, s99, v4
    v_xor_b32 v56, s100, v4
    v_xor_b32 v57, s101, v4
    s_mov_b64 exec, -1
    s_mov_b32 exec_lo, 0
    v_xor_b32 v32, s77, v4
    v_xor_b32 v33, s78, v4
    v_xor_b32 v34, s79, v4
    v_xor_b32 v35, s80, v4
    v_xor_b32 v36, s81, v4
    v_xor_b32 v37, s82, v4
    v_xor_b32 v38, s83, v4
    v_xor_b32 v39, s84, v4
    v_xor_b32 v40, s85, v4
    v_xor_b32 v41, s86, v4
    v_xor_b32 v42, s87, v4
    v_xor_b32 v43, s88, v4
    v_xor_b32 v44, s89, v4
    v_xor_b32 v45, s90, v4
    v_xor_b32 v46, s91, v4
    v_xor_b32 v47, s92, v4
    v_xor_b32 v48, s93, v4
    v_xor_b32 v49, s94, v4
    v_xor_b32 v50, s95, v4
    v_xor_b32 v51, s96, v4
    v_xor_b32 v52, s97, v4
    v_xor_b32 v53, s98, v4
    v_xor_b32 v54, s99, v4
    v_xor_b32 v55, s100, v4
    v_xor_b32 v56, s101, v4
    v_xor_b32 v57, s76, v4
    s_mov_b64 exec, -1
    s_branch L_help_x0
L_end:
    s_endpgm
.section .rodata,"a"
.p2align 6
.amdhsa_kernel standalone__deep_cross_xdeepfm__recsys_kernel
  .amdhsa_next_free_vgpr 256
  .amdhsa_next_free_sgpr 102
  .amdhsa_accum_offset 256
  .amdhsa_group_segment_fixed_size 0
  .amdhsa_kernarg_size 88
  .amdhsa_user_sgpr_count 2
  .amdhsa_user_sgpr_kernarg_segment_ptr 1
  .amdhsa_system_sgpr_workgroup_id_x 1
.end_amdhsa_kernel
```
